```python
import torch

def _softmax(x, axis=-1):
    return torch.softmax(x, dim=axis)

def _gelu(x):
    return torch.nn.functional.gelu(x, approximate='tanh')

def _silu(x):
    return torch.nn.functional.silu(x)

def _sigmoid(x):
    return torch.sigmoid(x)

def _layernorm(x, axis=-1, eps=1e-05):
    m = x.mean(dim=axis, keepdim=True)
    v = x.var(dim=axis, keepdim=True, unbiased=False)
    return (x - m) / torch.sqrt(v + eps)

def _scatter_add(tgt, idx, src, axis=0):
    return tgt.clone().index_add_(axis, idx, src)

def _segment_sum(src, seg, n):
    out = torch.zeros((n,) + src.shape[1:], dtype=src.dtype)
    return out.index_add_(0, seg, src)

def _pad(x, pw):
    flat = tuple((v for pair in reversed(pw) for v in pair))
    return torch.nn.functional.pad(x, flat)
kernel_name = 'adaLN_cond__ssm_conv_s4__moe_arch_mod__prompt'

def setup_inputs():

    _w = lambda a: (lambda t: t.to(torch.bfloat16) if t.is_floating_point() else t)(torch.as_tensor(a))

    def _A_setup():
        B, L, D, N = (1, 2048, 448, 256)
        A_re = -(lambda _x: torch.exp(torch.as_tensor(_x)))((lambda *s: torch.randn(*s, dtype=torch.bfloat16) * 12.8)(D, N))
        A_im = torch.pi * (lambda *s: torch.randn(*s, dtype=torch.bfloat16) * 0.05)(D, N)
        B_re = (lambda *s: torch.randn(*s, dtype=torch.bfloat16) * 0.1)(D, N)
        B_im = (lambda *s: torch.randn(*s, dtype=torch.bfloat16) * 0.1)(D, N)
        C_re = (lambda *s: torch.randn(*s, dtype=torch.bfloat16) * 0.1)(D, N)
        C_im = (lambda *s: torch.randn(*s, dtype=torch.bfloat16) * 0.1)(D, N)
        log_dt = (lambda *s: torch.randn(*s, dtype=torch.bfloat16) * 0.05)(D) * 0.5 - 4.0
        Dskip = (lambda *s: torch.randn(*s, dtype=torch.bfloat16) * 0.05)(D)
        return {'u': _w((lambda *s: torch.randn(*s, dtype=torch.bfloat16) * 0.05)(B, L, D)), 'A_re': _w(A_re), 'A_im': _w(A_im), 'B_re': _w(B_re), 'B_im': _w(B_im), 'C_re': _w(C_re), 'C_im': _w(C_im), 'log_dt': _w(log_dt), 'Dskip': _w(Dskip)}
    _A_in = _A_setup()

    def _B_setup():
        B, S, D, F, C = (1, 2048, 448, 1792, 8)
        return {'x': _w((lambda *s: torch.randn(*s, dtype=torch.bfloat16) * 0.05)(B, S, D)), 'w_r': _w((lambda *s: torch.randn(*s, dtype=torch.bfloat16) * 0.05)(D)), 'w_gate': _w((lambda *s: torch.randn(*s, dtype=torch.bfloat16) * 0.05)(D, F)), 'w_up': _w((lambda *s: torch.randn(*s, dtype=torch.bfloat16) * 0.05)(D, F)), 'w_down': _w((lambda *s: torch.randn(*s, dtype=torch.bfloat16) * 0.05)(F, D))}
    _B_in = _B_setup()
    return {'A_u': _A_in['u'], 'A_A_re': _A_in['A_re'], 'A_A_im': _A_in['A_im'], 'A_B_re': _A_in['B_re'], 'A_B_im': _A_in['B_im'], 'A_C_re': _A_in['C_re'], 'A_C_im': _A_in['C_im'], 'A_log_dt': _A_in['log_dt'], 'A_Dskip': _A_in['Dskip'], 'B_x': _B_in['x'], 'B_w_r': _B_in['w_r'], 'B_w_gate': _B_in['w_gate'], 'B_w_up': _B_in['w_up'], 'B_w_down': _B_in['w_down'], 'c': _w((lambda *s: torch.randn(*s, dtype=torch.bfloat16) * 0.1)(1, 448) * 8.0), 'w_mod': _w((lambda *s: torch.randn(*s, dtype=torch.bfloat16) * 0.1)(448, 6 * 448) * 448 ** (-0.5) * 8.0)}

def reference(A_u, A_A_re, A_A_im, A_B_re, A_B_im, A_C_re, A_C_im, A_log_dt, A_Dskip, B_x, B_w_r, B_w_gate, B_w_up, B_w_down, c, w_mod):

    def _A_ref(u, A_re, A_im, B_re, B_im, C_re, C_im, log_dt, Dskip):
        Bsz, L, D = u.shape
        dt = torch.exp(log_dt)[:, None]
        A = A_re + 1j * A_im
        Bc = B_re + 1j * B_im
        Cc = C_re + 1j * C_im
        logdA = dt * A
        dB = dt * Bc
        l = (lambda x, dt: x.to(dt))(torch.arange(L), A_re.dtype)
        P = torch.exp(logdA[:, :, None] * l[None, None, :])
        K = torch.einsum('dn,dnl,dn->dl', Cc, P, dB).real
        L2 = 2 * L
        Kp = _pad(K, ((0, 0), (0, L)))
        up = (lambda x, *d: x.permute(*d))(u, 0, 2, 1)
        up = _pad(up, ((0, 0), (0, 0), (0, L)))
        Kf = (lambda x, axes=(-2, -1): torch.fft.rfft2(x.float(), dim=axes))(Kp[:, None, :], axes=(-2, -1))
        Uf = (lambda x, axes=(-2, -1): torch.fft.rfft2(x.float(), dim=axes))(up[:, :, None, :], axes=(-2, -1))
        Yf = Uf * Kf[None, :, :, :]
        y = (lambda x, s, axes=(-2, -1): torch.fft.irfft2(x, s=s, dim=axes).to(torch.bfloat16))(Yf, (1, L2), axes=(-2, -1))[:, :, 0, :L]
        y = (lambda x, *d: x.permute(*d))(y, 0, 2, 1) + u * Dskip[None, None, :]
        return y

    def _B_ref(x, w_r, w_gate, w_up, w_down):
        B, S, D = x.shape
        C = 8
        r = x @ w_r
        idx = torch.argsort(-r, axis=-1)[:, :C]
        idx_e = (lambda x, n, axis: torch.repeat_interleave(x, n, dim=axis))(idx.reshape(B, C, 1), D, axis=2)
        x_sel = (lambda x, i, axis: torch.take_along_dim(x, i, dim=axis))(x, idx_e, axis=1)
        g = _silu(x_sel @ w_gate)
        u = x_sel @ w_up
        y = g * u @ w_down
        r_sel = _sigmoid((lambda x, i, axis: torch.take_along_dim(x, i, dim=axis))(r, idx, axis=1))
        y = y * r_sel.reshape(B, C, 1)
        b_off = (torch.arange(B) * S).reshape(B, 1)
        flat_idx = (idx + b_off).reshape(B * C)
        zero = (x * 0.0).reshape(B * S, D)
        upd = _scatter_add(zero, flat_idx, y.reshape(B * C, D), axis=0)
        return x + upd.reshape(B, S, D)
    x = A_u
    mod = (_silu(c) @ w_mod).reshape(c.shape[0], 6, 1, -1)
    sa, ca, ga, sb, cb, gb = (mod[:, 0].clone(), mod[:, 1].clone(), mod[:, 2].clone(), mod[:, 3].clone(), mod[:, 4].clone(), mod[:, 5].clone())
    h = _layernorm(x, axis=-1) * (1 + ca) + sa
    x = x + ga * _A_ref(h, A_A_re, A_A_im, A_B_re, A_B_im, A_C_re, A_C_im, A_log_dt, A_Dskip)
    h = _layernorm(x, axis=-1) * (1 + cb) + sb
    x = x + gb * _B_ref(h, B_w_r, B_w_gate, B_w_up, B_w_down)
    return x
```

```asm
; @launch kernel=k12_kernel grid=(256,1,1) block=(640,1,1) lds=158720
; @launch kernel=k3_kernel grid=(256,1,1) block=(448,1,1) lds=768
; @launch kernel=k4_kernel grid=(112,1,1) block=(704,1,1) lds=59392
; @launch kernel=k5_kernel grid=(56,1,1) block=(256,1,1) lds=1024
.amdgcn_target "amdgcn-amd-amdhsa--gfx950"
.text
.globl k12_kernel
.p2align 8
.type k12_kernel,@function
k12_kernel:
    s_cmp_ge_u32 s2, 256
    s_cbranch_scc1 KA_end
    s_load_dwordx16 s[8:23], s[0:1], 8
    s_load_dwordx2 s[4:5], s[0:1], 144
    s_load_dwordx2 s[62:63], s[0:1], 136
    s_load_dwordx2 s[6:7], s[0:1], 0
    s_load_dwordx4 s[48:51], s[0:1], 112
    v_lshrrev_b32 v4, 6, v0
    v_and_b32 v1, 63, v0
    v_readfirstlane_b32 s3, v4
    s_nop 0
    s_cmp_eq_u32 s3, 8
    s_cbranch_scc1 KA_ln
    s_cmp_eq_u32 s3, 9
    s_cbranch_scc1 KA_mod
    s_cmp_ge_u32 s2, 224
    s_cbranch_scc1 KA_rep
    s_mov_b32 s90, s2
    s_and_b32 s56, s2, 7
    s_lshr_b32 s57, s2, 5
    s_lshl_b32 s57, s57, 3
    s_add_u32 s56, s56, s57
    s_lshl_b32 s56, s56, 2
    s_bfe_u32 s57, s2, 0x20003
    s_add_u32 s2, s56, s57
    s_lshl_b32 s56, s2, 10
    v_lshlrev_b32 v5, 1, v0
    v_add_u32 v5, s56, v5
    v_and_b32 v2, 15, v1
    v_lshrrev_b32 v3, 4, v1
    s_mul_i32 s60, s3, 8704
    s_lshl_b32 s57, s2, 2
    s_waitcnt lgkmcnt(0)
    s_mov_b32 s24, s8
    s_mov_b32 s25, s9
    s_mov_b32 s26, 229376
    s_mov_b32 s27, 0x00020000
    s_mov_b32 s28, s10
    s_mov_b32 s29, s11
    s_mov_b32 s30, 229376
    s_mov_b32 s31, 0x00020000
    s_mov_b32 s32, s12
    s_mov_b32 s33, s13
    s_mov_b32 s34, 229376
    s_mov_b32 s35, 0x00020000
    s_mov_b32 s36, s14
    s_mov_b32 s37, s15
    s_mov_b32 s38, 229376
    s_mov_b32 s39, 0x00020000
    s_mov_b32 s40, s16
    s_mov_b32 s41, s17
    s_mov_b32 s42, 229376
    s_mov_b32 s43, 0x00020000
    s_mov_b32 s44, s18
    s_mov_b32 s45, s19
    s_mov_b32 s46, 229376
    s_mov_b32 s47, 0x00020000
    buffer_load_ushort v16, v5, s[24:27], 0 offen
    buffer_load_ushort v17, v5, s[28:31], 0 offen
    buffer_load_ushort v18, v5, s[32:35], 0 offen
    buffer_load_ushort v19, v5, s[36:39], 0 offen
    buffer_load_ushort v20, v5, s[40:43], 0 offen
    buffer_load_ushort v21, v5, s[44:47], 0 offen
    s_add_u32 s20, s20, s57
    s_addc_u32 s21, s21, 0
    s_load_dword s58, s[20:21], 0
    s_add_u32 s22, s22, s57
    s_addc_u32 s23, s23, 0
    s_load_dword s59, s[22:23], 0
    s_mov_b32 m0, s60
    s_branch KA_kgb
KA_ln:
    s_setprio 3
    s_waitcnt lgkmcnt(0)
    s_lshl_b32 s8, s2, 3
    v_lshrrev_b32 v7, 3, v1
    v_add_u32 v7, s8, v7
    v_and_b32 v2, 7, v1
    s_movk_i32 s9, 896
    v_mul_lo_u32 v3, v7, s9
    v_lshl_add_u32 v3, v2, 4, v3
    s_waitcnt lgkmcnt(0)
    s_mov_b32 s12, s6
    s_mov_b32 s13, s7
    s_mov_b32 s14, 1835008
    s_mov_b32 s15, 0x00020000
    s_add_u32 s16, s4, 2097152
    s_addc_u32 s17, s5, 0
    s_mov_b32 s18, 1835008
    s_mov_b32 s19, 0x00020000
    s_mov_b32 s24, s62
    s_mov_b32 s25, s63
    s_mov_b32 s26, 256
    s_mov_b32 s27, 0x00020000
    s_add_u32 s44, s4, 1966080
    s_addc_u32 s45, s5, 0
    s_mov_b32 s46, 8192
    s_mov_b32 s47, 0x00020000
    s_and_b32 s29, s2, 3
    s_lshl_b32 s29, s29, 2
    v_lshl_add_u32 v121, v1, 8, s29
    buffer_load_dword v120, v121, s[44:47], 0 offen sc1
    s_and_b32 s29, s2, 31
    s_lshl_b32 s29, s29, 8
    v_mov_b32 v122, s29
    buffer_load_dwordx4 v[124:127], v122, s[44:47], 0 offen sc1
    buffer_load_dwordx4 v[8:11], v3, s[12:15], 0 offen offset:0
    buffer_load_dwordx4 v[12:15], v3, s[12:15], 0 offen offset:128
    buffer_load_dwordx4 v[16:19], v3, s[12:15], 0 offen offset:256
    buffer_load_dwordx4 v[20:23], v3, s[12:15], 0 offen offset:384
    buffer_load_dwordx4 v[24:27], v3, s[12:15], 0 offen offset:512
    buffer_load_dwordx4 v[28:31], v3, s[12:15], 0 offen offset:640
    buffer_load_dwordx4 v[32:35], v3, s[12:15], 0 offen offset:768
    s_mov_b32 s20, 991054117
    s_mov_b32 s21, 925353388
    v_lshlrev_b32 v4, 15, v2
    v_lshl_add_u32 v4, v7, 4, v4
    s_branch KA_lnb
KA_mod:
    s_cmp_ge_u32 s2, 168
    s_cbranch_scc1 KA_end
    s_setprio 3
    s_waitcnt lgkmcnt(0)
    s_mov_b32 s28, s2
    s_lshr_b32 s36, s28, 2
    s_and_b32 s37, s28, 3
    s_mul_i32 s12, s37, 602112
    s_lshl_b32 s13, s36, 7
    s_add_u32 s12, s12, s13
    v_lshrrev_b32 v5, 3, v1
    v_and_b32 v2, 7, v1
    s_movk_i32 s14, 5376
    v_mul_lo_u32 v3, v5, s14
    v_lshl_add_u32 v3, v2, 4, v3
    v_add_u32 v3, s12, v3
    s_mul_i32 s15, s37, 224
    v_lshl_add_u32 v4, v5, 1, s15
    s_waitcnt lgkmcnt(0)
    s_mov_b32 s16, s48
    s_mov_b32 s17, s49
    s_mov_b32 s18, 896
    s_mov_b32 s19, 0x00020000
    s_mov_b32 s20, s50
    s_mov_b32 s21, s51
    s_mov_b32 s22, 2408448
    s_mov_b32 s23, 0x00020000
    s_add_u32 s24, s4, 1835008
    s_addc_u32 s25, s5, 0
    s_mov_b32 s26, 43008
    s_mov_b32 s27, 0x00020000
    s_mov_b32 s32, s62
    s_mov_b32 s33, s63
    s_mov_b32 s34, 256
    s_mov_b32 s35, 0x00020000
    s_add_u32 s44, s4, 1966080
    s_addc_u32 s45, s5, 0
    s_mov_b32 s46, 8192
    s_mov_b32 s47, 0x00020000
    s_and_b32 s29, s2, 3
    s_lshl_b32 s29, s29, 2
    v_lshl_add_u32 v121, v1, 8, s29
    buffer_load_dword v120, v121, s[44:47], 0 offen sc1
    s_and_b32 s29, s2, 31
    s_lshl_b32 s29, s29, 8
    v_mov_b32 v122, s29
    buffer_load_dwordx4 v[124:127], v122, s[44:47], 0 offen sc1
    buffer_load_ushort v8, v4, s[16:19], 0 offen offset:0
    buffer_load_ushort v9, v4, s[16:19], 0 offen offset:16
    buffer_load_ushort v10, v4, s[16:19], 0 offen offset:32
    buffer_load_ushort v11, v4, s[16:19], 0 offen offset:48
    buffer_load_ushort v12, v4, s[16:19], 0 offen offset:64
    buffer_load_ushort v13, v4, s[16:19], 0 offen offset:80
    buffer_load_ushort v14, v4, s[16:19], 0 offen offset:96
    buffer_load_ushort v15, v4, s[16:19], 0 offen offset:112
    buffer_load_ushort v16, v4, s[16:19], 0 offen offset:128
    buffer_load_ushort v17, v4, s[16:19], 0 offen offset:144
    buffer_load_ushort v18, v4, s[16:19], 0 offen offset:160
    buffer_load_ushort v19, v4, s[16:19], 0 offen offset:176
    buffer_load_ushort v20, v4, s[16:19], 0 offen offset:192
    buffer_load_ushort v21, v4, s[16:19], 0 offen offset:208
    s_mov_b32 s13, 0
    buffer_load_dwordx4 v[24:27], v3, s[20:23], s13 offen
    s_mov_b32 s13, 43008
    buffer_load_dwordx4 v[28:31], v3, s[20:23], s13 offen
    s_mov_b32 s13, 86016
    buffer_load_dwordx4 v[32:35], v3, s[20:23], s13 offen
    s_mov_b32 s13, 129024
    buffer_load_dwordx4 v[36:39], v3, s[20:23], s13 offen
    s_mov_b32 s13, 172032
    buffer_load_dwordx4 v[40:43], v3, s[20:23], s13 offen
    s_mov_b32 s13, 215040
    buffer_load_dwordx4 v[44:47], v3, s[20:23], s13 offen
    s_mov_b32 s13, 258048
    buffer_load_dwordx4 v[48:51], v3, s[20:23], s13 offen
    s_mov_b32 s13, 301056
    buffer_load_dwordx4 v[52:55], v3, s[20:23], s13 offen
    s_mov_b32 s13, 344064
    buffer_load_dwordx4 v[56:59], v3, s[20:23], s13 offen
    s_mov_b32 s13, 387072
    buffer_load_dwordx4 v[60:63], v3, s[20:23], s13 offen
    s_mov_b32 s13, 430080
    buffer_load_dwordx4 v[64:67], v3, s[20:23], s13 offen
    s_mov_b32 s13, 473088
    buffer_load_dwordx4 v[68:71], v3, s[20:23], s13 offen
    s_mov_b32 s13, 516096
    buffer_load_dwordx4 v[72:75], v3, s[20:23], s13 offen
    s_mov_b32 s13, 559104
    buffer_load_dwordx4 v[76:79], v3, s[20:23], s13 offen
    s_branch KA_modb
KA_kgb:
    v_lshrrev_b32 v10, 3, v2
    v_and_b32 v11, 7, v2
    v_lshl_add_u32 v7, v10, 7, v11
    v_lshrrev_b32 v12, 2, v11
    v_and_b32 v13, 3, v11
    v_lshlrev_b32 v13, 1, v13
    v_lshl_add_u32 v12, v12, 7, v13
    v_add_u32 v12, 256, v12
    v_lshrrev_b32 v13, 1, v11
    v_and_b32 v14, 1, v11
    v_lshlrev_b32 v14, 2, v14
    v_lshl_add_u32 v13, v13, 7, v14
    v_add_u32 v13, 512, v13
    v_cmp_eq_u32 vcc, 0, v10
    s_nop 1
    v_cndmask_b32 v8, v13, v12, vcc
    v_lshlrev_b32 v12, 7, v2
    v_add_u32 v12, 1024, v12
    v_cmp_ge_u32 vcc, 8, v2
    s_nop 1
    v_cndmask_b32 v9, 0, v12, vcc
    v_lshlrev_b32 v10, 2, v2
    v_add_u32 v10, 92800, v10
    ds_write_b32 v10, v7
    ds_write_b32 v10, v8 offset:64
    ds_write_b32 v10, v9 offset:128
    v_mul_u32_u24 v6, 544, v2
    v_lshl_add_u32 v6, v3, 4, v6
    v_add_u32 v6, s60, v6
    s_mov_b32 s52, 1069066811
    s_mov_b32 s53, 1042479491
    s_mov_b32 s50, 0x0000bf80
    s_mov_b32 s51, 0xbf800000
    s_lshr_b32 s57, s3, 2
    s_lshl_b32 s57, s57, 4
    s_waitcnt lgkmcnt(0)
    s_lshr_b32 s58, s58, s57
    s_lshl_b32 s58, s58, 16
    v_mov_b32 v10, s58
    v_mul_f32 v10, s52, v10
    v_exp_f32 v10, v10
    s_nop 0
    v_cvt_pk_bf16_f32 v10, v10, v10
    v_and_b32 v10, 0xffff0000, v10
    v_bfrev_b32 v24, 1
    s_and_b32 s54, s2, 3
    s_lshl_b32 s54, s54, 2
    v_lshl_add_u32 v90, v0, 4, s54
    v_lshrrev_b32 v25, 1, v1
    v_and_b32 v26, 1, v1
    v_mul_u32_u24 v27, 448, v25
    v_add_u32 v27, v27, v26
    s_lshl_b32 s54, s2, 1
    v_add_u32 v27, s54, v27
    v_lshlrev_b32 v89, 2, v27
    v_cmp_gt_u32 vcc, 12, v1
    s_nop 1
    v_cndmask_b32 v89, v24, v89, vcc
    v_lshlrev_b32 v88, 1, v27
    v_cmp_gt_u32 vcc, 12, v0
    s_nop 1
    v_cndmask_b32 v88, v24, v88, vcc
    v_and_b32 v28, 255, v0
    v_lshrrev_b32 v29, 8, v0
    v_mul_u32_u24 v30, 2624, v29
    v_add_u32 v30, 87552, v30
    v_lshlrev_b32 v31, 3, v28
    v_cmp_gt_u32 vcc, 128, v31
    v_add_u32 v32, 0, v31
    v_add_u32 v33, 1, v31
    v_cvt_f32_u32 v34, v32
    v_cvt_f32_u32 v35, v33
    v_cvt_pk_bf16_f32 v34, v34, v35
    v_lshrrev_b32 v35, 16, v34
    v_and_b32 v34, 0xffff, v34
    v_subrev_u32 v34, 17024, v34
    v_subrev_u32 v35, 17024, v35
    v_cndmask_b32 v34, v34, v32, vcc
    v_cndmask_b32 v35, v35, v33, vcc
    v_lshl_add_u32 v80, v34, 2, v30
    v_lshl_add_u32 v81, v35, 2, v30
    v_add_u32 v32, 2, v31
    v_add_u32 v33, 3, v31
    v_cvt_f32_u32 v34, v32
    v_cvt_f32_u32 v35, v33
    v_cvt_pk_bf16_f32 v34, v34, v35
    v_lshrrev_b32 v35, 16, v34
    v_and_b32 v34, 0xffff, v34
    v_subrev_u32 v34, 17024, v34
    v_subrev_u32 v35, 17024, v35
    v_cndmask_b32 v34, v34, v32, vcc
    v_cndmask_b32 v35, v35, v33, vcc
    v_lshl_add_u32 v82, v34, 2, v30
    v_lshl_add_u32 v83, v35, 2, v30
    v_add_u32 v32, 4, v31
    v_add_u32 v33, 5, v31
    v_cvt_f32_u32 v34, v32
    v_cvt_f32_u32 v35, v33
    v_cvt_pk_bf16_f32 v34, v34, v35
    v_lshrrev_b32 v35, 16, v34
    v_and_b32 v34, 0xffff, v34
    v_subrev_u32 v34, 17024, v34
    v_subrev_u32 v35, 17024, v35
    v_cndmask_b32 v34, v34, v32, vcc
    v_cndmask_b32 v35, v35, v33, vcc
    v_lshl_add_u32 v84, v34, 2, v30
    v_lshl_add_u32 v85, v35, 2, v30
    v_add_u32 v32, 6, v31
    v_add_u32 v33, 7, v31
    v_cvt_f32_u32 v34, v32
    v_cvt_f32_u32 v35, v33
    v_cvt_pk_bf16_f32 v34, v34, v35
    v_lshrrev_b32 v35, 16, v34
    v_and_b32 v34, 0xffff, v34
    v_subrev_u32 v34, 17024, v34
    v_subrev_u32 v35, 17024, v35
    v_cndmask_b32 v34, v34, v32, vcc
    v_cndmask_b32 v35, v35, v33, vcc
    v_lshl_add_u32 v86, v34, 2, v30
    v_lshl_add_u32 v87, v35, 2, v30
    v_lshrrev_b32 v36, 6, v0
    v_and_b32 v37, 3, v36
    v_and_b32 v39, 7, v1
    v_bfe_u32 v40, v1, 3, 1
    v_sub_u32 v41, 7, v39
    v_mul_u32_u24 v41, 4384, v41
    v_mul_u32_u24 v42, 35072, v29
    v_add_u32 v41, v41, v42
    v_lshl_add_u32 v41, v3, 4, v41
    v_lshlrev_b32 v42, 8, v40
    v_sub_u32 v41, v41, v42
    v_lshl_add_u32 v41, v37, 7, v41
    v_add_u32 v91, 256, v41
    v_add_u32 v43, v2, v3
    v_mul_u32_u24 v44, 8704, v29
    v_lshl_add_u32 v44, v43, 4, v44
    v_lshl_add_u32 v44, v37, 7, v44
    v_add_u32 v92, 70144, v44
    v_lshlrev_b32 v45, 15, v29
    v_lshl_add_u32 v45, v37, 13, v45
    v_lshl_add_u32 v45, v2, 5, v45
    v_lshrrev_b32 v42, 1, v3
    v_lshl_add_u32 v45, v42, 9, v45
    v_and_b32 v42, 1, v3
    v_lshl_add_u32 v45, v42, 4, v45
    v_add_u32 v93, 93184, v45
    s_and_b32 s61, s3, 3
    s_lshl_b32 s54, s61, 6
    s_add_u32 s54, s54, 92800
    v_lshlrev_b32 v46, 4, v3
    v_add_u32 v46, s54, v46
    ds_read_b128 v[48:51], v46
    s_lshr_b32 s55, s3, 2
    s_mul_i32 s55, s55, 2624
    s_add_u32 s55, s55, 87552
    v_lshlrev_b32 v47, 3, v2
    s_cmp_eq_u32 s61, 2
    s_cselect_b64 s[48:49], -1, 0
    v_mov_b32 v52, 92992
    v_lshlrev_b32 v53, 4, v0
    v_add_u32 v53, 93184, v53
    ds_write_b128 v53, v[80:83]
    ds_write_b128 v53, v[84:87] offset:8192
    ds_write_b128 v53, v[88:91] offset:16384
    ds_write_b128 v53, v[92:95] offset:24576
    s_waitcnt lgkmcnt(4)
    v_add_u32 v54, v48, v47
    v_cvt_f32_u32 v96, v54
    v_lshrrev_b32 v96, 16, v96
    v_subrev_u32 v96, 17024, v96
    v_cmp_gt_u32 vcc, 128, v54
    s_nop 1
    v_cndmask_b32 v96, v96, v54, vcc
    v_lshl_add_u32 v96, v96, 2, s55
    v_cmp_lt_u32 vcc, 2048, v54
    s_nop 1
    v_cndmask_b32 v96, v96, v52, vcc
    v_cmp_eq_u32 vcc, 0, v48
    s_nop 0
    s_and_b64 vcc, vcc, s[48:49]
    v_cndmask_b32 v96, v96, v52, vcc
    v_add_u32 v54, v49, v47
    v_cvt_f32_u32 v97, v54
    v_lshrrev_b32 v97, 16, v97
    v_subrev_u32 v97, 17024, v97
    v_cmp_gt_u32 vcc, 128, v54
    s_nop 1
    v_cndmask_b32 v97, v97, v54, vcc
    v_lshl_add_u32 v97, v97, 2, s55
    v_cmp_lt_u32 vcc, 2048, v54
    s_nop 1
    v_cndmask_b32 v97, v97, v52, vcc
    v_cmp_eq_u32 vcc, 0, v49
    s_nop 0
    s_and_b64 vcc, vcc, s[48:49]
    v_cndmask_b32 v97, v97, v52, vcc
    v_add_u32 v54, v50, v47
    v_cvt_f32_u32 v98, v54
    v_lshrrev_b32 v98, 16, v98
    v_subrev_u32 v98, 17024, v98
    v_cmp_gt_u32 vcc, 128, v54
    s_nop 1
    v_cndmask_b32 v98, v98, v54, vcc
    v_lshl_add_u32 v98, v98, 2, s55
    v_cmp_lt_u32 vcc, 2048, v54
    s_nop 1
    v_cndmask_b32 v98, v98, v52, vcc
    v_cmp_eq_u32 vcc, 0, v50
    s_nop 0
    s_and_b64 vcc, vcc, s[48:49]
    v_cndmask_b32 v98, v98, v52, vcc
    v_add_u32 v54, v51, v47
    v_cvt_f32_u32 v99, v54
    v_lshrrev_b32 v99, 16, v99
    v_subrev_u32 v99, 17024, v99
    v_cmp_gt_u32 vcc, 128, v54
    s_nop 1
    v_cndmask_b32 v99, v99, v54, vcc
    v_lshl_add_u32 v99, v99, 2, s55
    v_cmp_lt_u32 vcc, 2048, v54
    s_nop 1
    v_cndmask_b32 v99, v99, v52, vcc
    v_cmp_eq_u32 vcc, 0, v51
    s_nop 0
    s_and_b64 vcc, vcc, s[48:49]
    v_cndmask_b32 v99, v99, v52, vcc
    ds_write_b128 v53, v[96:99] offset:32768
    s_waitcnt vmcnt(0)
    v_lshlrev_b32 v16, 16, v16
    v_lshlrev_b32 v17, 16, v17
    v_lshlrev_b32 v18, 16, v18
    v_lshlrev_b32 v19, 16, v19
    v_lshlrev_b32 v20, 16, v20
    v_lshlrev_b32 v21, 16, v21
    v_mul_f32 v16, v10, v16
    v_mul_f32 v17, v10, v17
    v_mul_f32 v18, v10, v18
    v_mul_f32 v19, v10, v19
    v_mul_f32 v16, s52, v16
    v_mul_f32 v17, s53, v17
    v_mul_f32 v64, 1.0, v16
    v_mul_f32 v68, 1.0, v17
    v_mul_f32 v65, 8.0, v16
    v_mul_f32 v69, 8.0, v17
    v_mul_f32 v66, 128.0, v16
    v_mul_f32 v70, 128.0, v17
    v_mul_f32 v67, 1024.0, v16
    v_mul_f32 v71, 1024.0, v17
    v_exp_f32 v64, v64
    v_fract_f32 v68, v68
    v_exp_f32 v65, v65
    v_fract_f32 v69, v69
    v_exp_f32 v66, v66
    v_fract_f32 v70, v70
    v_exp_f32 v67, v67
    v_fract_f32 v71, v71
    v_cos_f32 v24, v68
    v_sin_f32 v25, v68
    v_cos_f32 v30, v69
    v_sin_f32 v31, v69
    v_cos_f32 v38, v70
    v_sin_f32 v39, v70
    v_cos_f32 v44, v71
    v_sin_f32 v45, v71
    v_pk_mul_f32 v[72:73], v[20:21], v[18:19] op_sel_hi:[1,0]
    v_pk_fma_f32 v[72:73], v[20:21], v[18:19], v[72:73] op_sel:[1,1,0] op_sel_hi:[0,1,1] neg_lo:[1,0,0]
    v_xor_b32 v73, 0x80000000, v73
    v_mul_f32 v24, v64, v24
    v_mul_f32 v25, v64, v25
    v_mul_f32 v30, v65, v30
    v_mul_f32 v31, v65, v31
    v_mul_f32 v38, v66, v38
    v_mul_f32 v39, v66, v39
    v_mul_f32 v44, v67, v44
    v_mul_f32 v45, v67, v45
    v_pk_mul_f32 v[32:33], v[30:31], v[30:31] op_sel_hi:[1,0]
    v_pk_fma_f32 v[32:33], v[30:31], v[30:31], v[32:33] op_sel:[1,1,0] op_sel_hi:[0,1,1] neg_lo:[1,0,0]
    v_pk_mul_f32 v[26:27], v[24:25], v[24:25] op_sel_hi:[1,0]
    v_pk_fma_f32 v[26:27], v[24:25], v[24:25], v[26:27] op_sel:[1,1,0] op_sel_hi:[0,1,1] neg_lo:[1,0,0]
    v_pk_mul_f32 v[40:41], v[38:39], v[38:39] op_sel_hi:[1,0]
    v_pk_fma_f32 v[40:41], v[38:39], v[38:39], v[40:41] op_sel:[1,1,0] op_sel_hi:[0,1,1] neg_lo:[1,0,0]
    v_pk_mul_f32 v[46:47], v[44:45], v[44:45] op_sel_hi:[1,0]
    v_pk_fma_f32 v[46:47], v[44:45], v[44:45], v[46:47] op_sel:[1,1,0] op_sel_hi:[0,1,1] neg_lo:[1,0,0]
    v_pk_mul_f32 v[34:35], v[32:33], v[32:33] op_sel_hi:[1,0]
    v_pk_fma_f32 v[34:35], v[32:33], v[32:33], v[34:35] op_sel:[1,1,0] op_sel_hi:[0,1,1] neg_lo:[1,0,0]
    v_pk_mul_f32 v[28:29], v[26:27], v[26:27] op_sel_hi:[1,0]
    v_pk_fma_f32 v[28:29], v[26:27], v[26:27], v[28:29] op_sel:[1,1,0] op_sel_hi:[0,1,1] neg_lo:[1,0,0]
    v_pk_mul_f32 v[42:43], v[40:41], v[40:41] op_sel_hi:[1,0]
    v_pk_fma_f32 v[42:43], v[40:41], v[40:41], v[42:43] op_sel:[1,1,0] op_sel_hi:[0,1,1] neg_lo:[1,0,0]
    v_pk_mul_f32 v[36:37], v[34:35], v[34:35] op_sel_hi:[1,0]
    v_pk_fma_f32 v[36:37], v[34:35], v[34:35], v[36:37] op_sel:[1,1,0] op_sel_hi:[0,1,1] neg_lo:[1,0,0]
    v_pk_mul_f32 v[74:75], v[72:73], v[30:31] op_sel_hi:[1,0]
    v_pk_fma_f32 v[74:75], v[72:73], v[30:31], v[74:75] op_sel:[1,1,0] op_sel_hi:[0,1,1] neg_hi:[1,0,0]
    v_pk_mul_f32 v[76:77], v[72:73], v[32:33] op_sel_hi:[1,0]
    v_pk_fma_f32 v[76:77], v[72:73], v[32:33], v[76:77] op_sel:[1,1,0] op_sel_hi:[0,1,1] neg_hi:[1,0,0]
    v_pk_mul_f32 v[78:79], v[74:75], v[32:33] op_sel_hi:[1,0]
    v_pk_fma_f32 v[78:79], v[74:75], v[32:33], v[78:79] op_sel:[1,1,0] op_sel_hi:[0,1,1] neg_hi:[1,0,0]
    v_pk_mul_f32 v[80:81], v[72:73], v[34:35] op_sel_hi:[1,0]
    v_pk_fma_f32 v[80:81], v[72:73], v[34:35], v[80:81] op_sel:[1,1,0] op_sel_hi:[0,1,1] neg_hi:[1,0,0]
    v_pk_mul_f32 v[82:83], v[74:75], v[34:35] op_sel_hi:[1,0]
    v_pk_fma_f32 v[82:83], v[74:75], v[34:35], v[82:83] op_sel:[1,1,0] op_sel_hi:[0,1,1] neg_hi:[1,0,0]
    v_pk_mul_f32 v[84:85], v[76:77], v[34:35] op_sel_hi:[1,0]
    v_pk_fma_f32 v[84:85], v[76:77], v[34:35], v[84:85] op_sel:[1,1,0] op_sel_hi:[0,1,1] neg_hi:[1,0,0]
    v_pk_mul_f32 v[86:87], v[78:79], v[34:35] op_sel_hi:[1,0]
    v_pk_fma_f32 v[86:87], v[78:79], v[34:35], v[86:87] op_sel:[1,1,0] op_sel_hi:[0,1,1] neg_hi:[1,0,0]
    v_pk_mul_f32 v[88:89], v[72:73], v[36:37] op_sel_hi:[1,0]
    v_pk_fma_f32 v[88:89], v[72:73], v[36:37], v[88:89] op_sel:[1,1,0] op_sel_hi:[0,1,1] neg_hi:[1,0,0]
    v_pk_mul_f32 v[90:91], v[74:75], v[36:37] op_sel_hi:[1,0]
    v_pk_fma_f32 v[90:91], v[74:75], v[36:37], v[90:91] op_sel:[1,1,0] op_sel_hi:[0,1,1] neg_hi:[1,0,0]
    v_pk_mul_f32 v[92:93], v[76:77], v[36:37] op_sel_hi:[1,0]
    v_pk_fma_f32 v[92:93], v[76:77], v[36:37], v[92:93] op_sel:[1,1,0] op_sel_hi:[0,1,1] neg_hi:[1,0,0]
    v_pk_mul_f32 v[94:95], v[78:79], v[36:37] op_sel_hi:[1,0]
    v_pk_fma_f32 v[94:95], v[78:79], v[36:37], v[94:95] op_sel:[1,1,0] op_sel_hi:[0,1,1] neg_hi:[1,0,0]
    v_pk_mul_f32 v[96:97], v[80:81], v[36:37] op_sel_hi:[1,0]
    v_pk_fma_f32 v[96:97], v[80:81], v[36:37], v[96:97] op_sel:[1,1,0] op_sel_hi:[0,1,1] neg_hi:[1,0,0]
    v_pk_mul_f32 v[98:99], v[82:83], v[36:37] op_sel_hi:[1,0]
    v_pk_fma_f32 v[98:99], v[82:83], v[36:37], v[98:99] op_sel:[1,1,0] op_sel_hi:[0,1,1] neg_hi:[1,0,0]
    v_pk_mul_f32 v[100:101], v[84:85], v[36:37] op_sel_hi:[1,0]
    v_pk_fma_f32 v[100:101], v[84:85], v[36:37], v[100:101] op_sel:[1,1,0] op_sel_hi:[0,1,1] neg_hi:[1,0,0]
    v_pk_mul_f32 v[102:103], v[86:87], v[36:37] op_sel_hi:[1,0]
    v_pk_fma_f32 v[102:103], v[86:87], v[36:37], v[102:103] op_sel:[1,1,0] op_sel_hi:[0,1,1] neg_hi:[1,0,0]
    v_cvt_pk_bf16_f32 v104, v72, v73
    v_dot2_f32_bf16 v108, v104, s50, v72
    v_dot2_f32_bf16 v109, v104, s51, v73
    v_mov_b32 v72, v104
    v_cvt_pk_bf16_f32 v105, v74, v75
    v_dot2_f32_bf16 v110, v105, s50, v74
    v_dot2_f32_bf16 v111, v105, s51, v75
    v_cvt_pk_bf16_f32 v73, v108, v109
    v_mov_b32 v74, v105
    v_cvt_pk_bf16_f32 v106, v76, v77
    v_dot2_f32_bf16 v112, v106, s50, v76
    v_dot2_f32_bf16 v113, v106, s51, v77
    v_cvt_pk_bf16_f32 v75, v110, v111
    v_mov_b32 v76, v106
    ds_write_addtid_b32 v72 offset:0
    ds_write_addtid_b32 v73 offset:256
    v_cvt_pk_bf16_f32 v104, v78, v79
    v_dot2_f32_bf16 v108, v104, s50, v78
    v_dot2_f32_bf16 v109, v104, s51, v79
    v_cvt_pk_bf16_f32 v77, v112, v113
    v_mov_b32 v78, v104
    ds_write_addtid_b32 v74 offset:544
    ds_write_addtid_b32 v75 offset:800
    v_cvt_pk_bf16_f32 v105, v80, v81
    v_dot2_f32_bf16 v110, v105, s50, v80
    v_dot2_f32_bf16 v111, v105, s51, v81
    v_cvt_pk_bf16_f32 v79, v108, v109
    v_mov_b32 v80, v105
    ds_write_addtid_b32 v76 offset:1088
    ds_write_addtid_b32 v77 offset:1344
    v_cvt_pk_bf16_f32 v106, v82, v83
    v_dot2_f32_bf16 v112, v106, s50, v82
    v_dot2_f32_bf16 v113, v106, s51, v83
    v_cvt_pk_bf16_f32 v81, v110, v111
    v_mov_b32 v82, v106
    ds_write_addtid_b32 v78 offset:1632
    ds_write_addtid_b32 v79 offset:1888
    v_cvt_pk_bf16_f32 v104, v84, v85
    v_dot2_f32_bf16 v108, v104, s50, v84
    v_dot2_f32_bf16 v109, v104, s51, v85
    v_cvt_pk_bf16_f32 v83, v112, v113
    v_mov_b32 v84, v104
    ds_write_addtid_b32 v80 offset:2176
    ds_write_addtid_b32 v81 offset:2432
    v_cvt_pk_bf16_f32 v105, v86, v87
    v_dot2_f32_bf16 v110, v105, s50, v86
    v_dot2_f32_bf16 v111, v105, s51, v87
    v_cvt_pk_bf16_f32 v85, v108, v109
    v_mov_b32 v86, v105
    ds_write_addtid_b32 v82 offset:2720
    ds_write_addtid_b32 v83 offset:2976
    v_cvt_pk_bf16_f32 v106, v88, v89
    v_dot2_f32_bf16 v112, v106, s50, v88
    v_dot2_f32_bf16 v113, v106, s51, v89
    v_cvt_pk_bf16_f32 v87, v110, v111
    v_mov_b32 v88, v106
    ds_write_addtid_b32 v84 offset:3264
    ds_write_addtid_b32 v85 offset:3520
    v_cvt_pk_bf16_f32 v104, v90, v91
    v_dot2_f32_bf16 v108, v104, s50, v90
    v_dot2_f32_bf16 v109, v104, s51, v91
    v_cvt_pk_bf16_f32 v89, v112, v113
    v_mov_b32 v90, v104
    ds_write_addtid_b32 v86 offset:3808
    ds_write_addtid_b32 v87 offset:4064
    v_cvt_pk_bf16_f32 v105, v92, v93
    v_dot2_f32_bf16 v110, v105, s50, v92
    v_dot2_f32_bf16 v111, v105, s51, v93
    v_cvt_pk_bf16_f32 v91, v108, v109
    v_mov_b32 v92, v105
    ds_write_addtid_b32 v88 offset:4352
    ds_write_addtid_b32 v89 offset:4608
    v_cvt_pk_bf16_f32 v106, v94, v95
    v_dot2_f32_bf16 v112, v106, s50, v94
    v_dot2_f32_bf16 v113, v106, s51, v95
    v_cvt_pk_bf16_f32 v93, v110, v111
    v_mov_b32 v94, v106
    ds_write_addtid_b32 v90 offset:4896
    ds_write_addtid_b32 v91 offset:5152
    v_cvt_pk_bf16_f32 v104, v96, v97
    v_dot2_f32_bf16 v108, v104, s50, v96
    v_dot2_f32_bf16 v109, v104, s51, v97
    v_cvt_pk_bf16_f32 v95, v112, v113
    v_mov_b32 v96, v104
    ds_write_addtid_b32 v92 offset:5440
    ds_write_addtid_b32 v93 offset:5696
    v_cvt_pk_bf16_f32 v105, v98, v99
    v_dot2_f32_bf16 v110, v105, s50, v98
    v_dot2_f32_bf16 v111, v105, s51, v99
    v_cvt_pk_bf16_f32 v97, v108, v109
    v_mov_b32 v98, v105
    ds_write_addtid_b32 v94 offset:5984
    ds_write_addtid_b32 v95 offset:6240
    v_cvt_pk_bf16_f32 v106, v100, v101
    v_dot2_f32_bf16 v112, v106, s50, v100
    v_dot2_f32_bf16 v113, v106, s51, v101
    v_cvt_pk_bf16_f32 v99, v110, v111
    v_mov_b32 v100, v106
    ds_write_addtid_b32 v96 offset:6528
    ds_write_addtid_b32 v97 offset:6784
    v_cvt_pk_bf16_f32 v104, v102, v103
    v_dot2_f32_bf16 v108, v104, s50, v102
    v_dot2_f32_bf16 v109, v104, s51, v103
    v_cvt_pk_bf16_f32 v101, v112, v113
    v_mov_b32 v102, v104
    ds_write_addtid_b32 v98 offset:7072
    ds_write_addtid_b32 v99 offset:7328
    v_pk_mul_f32 v[48:49], v[24:25], v[26:27] op_sel_hi:[1,0]
    v_pk_fma_f32 v[48:49], v[24:25], v[26:27], v[48:49] op_sel:[1,1,0] op_sel_hi:[0,1,1] neg_lo:[1,0,0]
    v_cvt_pk_bf16_f32 v103, v108, v109
    v_pk_mul_f32 v[50:51], v[24:25], v[28:29] op_sel_hi:[1,0]
    v_pk_fma_f32 v[50:51], v[24:25], v[28:29], v[50:51] op_sel:[1,1,0] op_sel_hi:[0,1,1] neg_lo:[1,0,0]
    ds_write_addtid_b32 v100 offset:7616
    ds_write_addtid_b32 v101 offset:7872
    ds_write_addtid_b32 v102 offset:8160
    ds_write_addtid_b32 v103 offset:8416
    v_pk_mul_f32 v[52:53], v[26:27], v[28:29] op_sel_hi:[1,0]
    v_pk_fma_f32 v[52:53], v[26:27], v[28:29], v[52:53] op_sel:[1,1,0] op_sel_hi:[0,1,1] neg_lo:[1,0,0]
    v_pk_mul_f32 v[56:57], v[40:41], v[38:39] op_sel_hi:[1,0]
    v_pk_fma_f32 v[56:57], v[40:41], v[38:39], v[56:57] op_sel:[1,1,0] op_sel_hi:[0,1,1] neg_lo:[1,0,0]
    v_pk_mul_f32 v[54:55], v[48:49], v[28:29] op_sel_hi:[1,0]
    v_pk_fma_f32 v[54:55], v[48:49], v[28:29], v[54:55] op_sel:[1,1,0] op_sel_hi:[0,1,1] neg_lo:[1,0,0]
    v_pk_mul_f32 v[58:59], v[42:43], v[38:39] op_sel_hi:[1,0]
    v_pk_fma_f32 v[58:59], v[42:43], v[38:39], v[58:59] op_sel:[1,1,0] op_sel_hi:[0,1,1] neg_lo:[1,0,0]
    v_pk_mul_f32 v[60:61], v[42:43], v[40:41] op_sel_hi:[1,0]
    v_pk_fma_f32 v[60:61], v[42:43], v[40:41], v[60:61] op_sel:[1,1,0] op_sel_hi:[0,1,1] neg_lo:[1,0,0]
    v_pk_mul_f32 v[62:63], v[42:43], v[56:57] op_sel_hi:[1,0]
    v_pk_fma_f32 v[62:63], v[42:43], v[56:57], v[62:63] op_sel:[1,1,0] op_sel_hi:[0,1,1] neg_lo:[1,0,0]
    s_waitcnt lgkmcnt(0)
    ds_read_b128 v[116:119], v6 offset:0
    ds_read_b128 v[120:123], v6 offset:256
    ds_read_b128 v[124:127], v6 offset:64
    ds_read_b128 v[128:131], v6 offset:320
    ds_read_b128 v[132:135], v6 offset:128
    ds_read_b128 v[136:139], v6 offset:384
    ds_read_b128 v[140:143], v6 offset:192
    ds_read_b128 v[144:147], v6 offset:448
    v_mov_b32 v72, 0x3f80
    v_mov_b32 v73, 0
    v_cvt_pk_bf16_f32 v105, v24, v25
    v_dot2_f32_bf16 v110, v105, s50, v24
    v_dot2_f32_bf16 v111, v105, s51, v25
    v_mov_b32 v74, v105
    v_cvt_pk_bf16_f32 v106, v26, v27
    v_dot2_f32_bf16 v112, v106, s50, v26
    v_dot2_f32_bf16 v113, v106, s51, v27
    v_cvt_pk_bf16_f32 v75, v110, v111
    v_mov_b32 v76, v106
    v_cvt_pk_bf16_f32 v104, v48, v49
    v_dot2_f32_bf16 v108, v104, s50, v48
    v_dot2_f32_bf16 v109, v104, s51, v49
    v_cvt_pk_bf16_f32 v77, v112, v113
    v_mov_b32 v78, v104
    v_cvt_pk_bf16_f32 v105, v28, v29
    v_dot2_f32_bf16 v110, v105, s50, v28
    v_dot2_f32_bf16 v111, v105, s51, v29
    v_cvt_pk_bf16_f32 v79, v108, v109
    v_mov_b32 v80, v105
    v_cvt_pk_bf16_f32 v106, v50, v51
    v_dot2_f32_bf16 v112, v106, s50, v50
    v_dot2_f32_bf16 v113, v106, s51, v51
    v_cvt_pk_bf16_f32 v81, v110, v111
    v_mov_b32 v82, v106
    v_cvt_pk_bf16_f32 v104, v52, v53
    v_dot2_f32_bf16 v108, v104, s50, v52
    v_dot2_f32_bf16 v109, v104, s51, v53
    v_cvt_pk_bf16_f32 v83, v112, v113
    v_mov_b32 v84, v104
    v_cvt_pk_bf16_f32 v105, v54, v55
    v_dot2_f32_bf16 v110, v105, s50, v54
    v_dot2_f32_bf16 v111, v105, s51, v55
    v_cvt_pk_bf16_f32 v85, v108, v109
    v_mov_b32 v86, v105
    v_cvt_pk_bf16_f32 v106, v38, v39
    v_dot2_f32_bf16 v112, v106, s50, v38
    v_dot2_f32_bf16 v113, v106, s51, v39
    v_cvt_pk_bf16_f32 v87, v110, v111
    v_mov_b32 v88, v106
    v_pk_mul_f32 v[90:91], v[38:39], v[24:25] op_sel_hi:[1,0]
    v_pk_fma_f32 v[90:91], v[38:39], v[24:25], v[90:91] op_sel:[1,1,0] op_sel_hi:[0,1,1] neg_lo:[1,0,0]
    v_cvt_pk_bf16_f32 v104, v90, v91
    v_dot2_f32_bf16 v108, v104, s50, v90
    v_dot2_f32_bf16 v109, v104, s51, v91
    v_cvt_pk_bf16_f32 v89, v112, v113
    v_mov_b32 v90, v104
    v_pk_mul_f32 v[92:93], v[38:39], v[26:27] op_sel_hi:[1,0]
    v_pk_fma_f32 v[92:93], v[38:39], v[26:27], v[92:93] op_sel:[1,1,0] op_sel_hi:[0,1,1] neg_lo:[1,0,0]
    v_cvt_pk_bf16_f32 v105, v92, v93
    v_dot2_f32_bf16 v110, v105, s50, v92
    v_dot2_f32_bf16 v111, v105, s51, v93
    v_cvt_pk_bf16_f32 v91, v108, v109
    v_mov_b32 v92, v105
    v_pk_mul_f32 v[94:95], v[38:39], v[48:49] op_sel_hi:[1,0]
    v_pk_fma_f32 v[94:95], v[38:39], v[48:49], v[94:95] op_sel:[1,1,0] op_sel_hi:[0,1,1] neg_lo:[1,0,0]
    v_cvt_pk_bf16_f32 v106, v94, v95
    v_dot2_f32_bf16 v112, v106, s50, v94
    v_dot2_f32_bf16 v113, v106, s51, v95
    v_cvt_pk_bf16_f32 v93, v110, v111
    v_mov_b32 v94, v106
    v_pk_mul_f32 v[96:97], v[38:39], v[28:29] op_sel_hi:[1,0]
    v_pk_fma_f32 v[96:97], v[38:39], v[28:29], v[96:97] op_sel:[1,1,0] op_sel_hi:[0,1,1] neg_lo:[1,0,0]
    v_cvt_pk_bf16_f32 v104, v96, v97
    v_dot2_f32_bf16 v108, v104, s50, v96
    v_dot2_f32_bf16 v109, v104, s51, v97
    v_cvt_pk_bf16_f32 v95, v112, v113
    v_mov_b32 v96, v104
    v_pk_mul_f32 v[98:99], v[38:39], v[50:51] op_sel_hi:[1,0]
    v_pk_fma_f32 v[98:99], v[38:39], v[50:51], v[98:99] op_sel:[1,1,0] op_sel_hi:[0,1,1] neg_lo:[1,0,0]
    v_cvt_pk_bf16_f32 v105, v98, v99
    v_dot2_f32_bf16 v110, v105, s50, v98
    v_dot2_f32_bf16 v111, v105, s51, v99
    v_cvt_pk_bf16_f32 v97, v108, v109
    v_mov_b32 v98, v105
    v_pk_mul_f32 v[100:101], v[38:39], v[52:53] op_sel_hi:[1,0]
    v_pk_fma_f32 v[100:101], v[38:39], v[52:53], v[100:101] op_sel:[1,1,0] op_sel_hi:[0,1,1] neg_lo:[1,0,0]
    v_cvt_pk_bf16_f32 v106, v100, v101
    v_dot2_f32_bf16 v112, v106, s50, v100
    v_dot2_f32_bf16 v113, v106, s51, v101
    v_cvt_pk_bf16_f32 v99, v110, v111
    v_mov_b32 v100, v106
    v_pk_mul_f32 v[102:103], v[38:39], v[54:55] op_sel_hi:[1,0]
    v_pk_fma_f32 v[102:103], v[38:39], v[54:55], v[102:103] op_sel:[1,1,0] op_sel_hi:[0,1,1] neg_lo:[1,0,0]
    v_cvt_pk_bf16_f32 v104, v102, v103
    v_dot2_f32_bf16 v108, v104, s50, v102
    v_dot2_f32_bf16 v109, v104, s51, v103
    v_cvt_pk_bf16_f32 v101, v112, v113
    v_mov_b32 v102, v104
    s_nop 0
    v_cvt_pk_bf16_f32 v103, v108, v109
    s_waitcnt lgkmcnt(0)
    ds_write_addtid_b32 v72 offset:0
    ds_write_addtid_b32 v73 offset:256
    ds_write_addtid_b32 v74 offset:544
    ds_write_addtid_b32 v75 offset:800
    ds_write_addtid_b32 v76 offset:1088
    ds_write_addtid_b32 v77 offset:1344
    ds_write_addtid_b32 v78 offset:1632
    ds_write_addtid_b32 v79 offset:1888
    ds_write_addtid_b32 v80 offset:2176
    ds_write_addtid_b32 v81 offset:2432
    ds_write_addtid_b32 v82 offset:2720
    ds_write_addtid_b32 v83 offset:2976
    ds_write_addtid_b32 v84 offset:3264
    ds_write_addtid_b32 v85 offset:3520
    ds_write_addtid_b32 v86 offset:3808
    ds_write_addtid_b32 v87 offset:4064
    ds_write_addtid_b32 v88 offset:4352
    ds_write_addtid_b32 v89 offset:4608
    ds_write_addtid_b32 v90 offset:4896
    ds_write_addtid_b32 v91 offset:5152
    ds_write_addtid_b32 v92 offset:5440
    ds_write_addtid_b32 v93 offset:5696
    ds_write_addtid_b32 v94 offset:5984
    ds_write_addtid_b32 v95 offset:6240
    ds_write_addtid_b32 v96 offset:6528
    ds_write_addtid_b32 v97 offset:6784
    ds_write_addtid_b32 v98 offset:7072
    ds_write_addtid_b32 v99 offset:7328
    ds_write_addtid_b32 v100 offset:7616
    ds_write_addtid_b32 v101 offset:7872
    ds_write_addtid_b32 v102 offset:8160
    ds_write_addtid_b32 v103 offset:8416
    v_cvt_pk_bf16_f32 v105, v40, v41
    v_dot2_f32_bf16 v110, v105, s50, v40
    v_dot2_f32_bf16 v111, v105, s51, v41
    v_mov_b32 v72, v105
    v_pk_mul_f32 v[74:75], v[40:41], v[26:27] op_sel_hi:[1,0]
    v_pk_fma_f32 v[74:75], v[40:41], v[26:27], v[74:75] op_sel:[1,1,0] op_sel_hi:[0,1,1] neg_lo:[1,0,0]
    v_cvt_pk_bf16_f32 v106, v74, v75
    v_dot2_f32_bf16 v112, v106, s50, v74
    v_dot2_f32_bf16 v113, v106, s51, v75
    v_cvt_pk_bf16_f32 v73, v110, v111
    v_mov_b32 v74, v106
    v_pk_mul_f32 v[76:77], v[40:41], v[28:29] op_sel_hi:[1,0]
    v_pk_fma_f32 v[76:77], v[40:41], v[28:29], v[76:77] op_sel:[1,1,0] op_sel_hi:[0,1,1] neg_lo:[1,0,0]
    v_cvt_pk_bf16_f32 v104, v76, v77
    v_dot2_f32_bf16 v108, v104, s50, v76
    v_dot2_f32_bf16 v109, v104, s51, v77
    v_cvt_pk_bf16_f32 v75, v112, v113
    v_mov_b32 v76, v104
    v_pk_mul_f32 v[78:79], v[40:41], v[52:53] op_sel_hi:[1,0]
    v_pk_fma_f32 v[78:79], v[40:41], v[52:53], v[78:79] op_sel:[1,1,0] op_sel_hi:[0,1,1] neg_lo:[1,0,0]
    v_cvt_pk_bf16_f32 v105, v78, v79
    v_dot2_f32_bf16 v110, v105, s50, v78
    v_dot2_f32_bf16 v111, v105, s51, v79
    v_cvt_pk_bf16_f32 v77, v108, v109
    v_mov_b32 v78, v105
    v_cvt_pk_bf16_f32 v106, v56, v57
    v_dot2_f32_bf16 v112, v106, s50, v56
    v_dot2_f32_bf16 v113, v106, s51, v57
    v_cvt_pk_bf16_f32 v79, v110, v111
    v_mov_b32 v80, v106
    v_pk_mul_f32 v[82:83], v[56:57], v[26:27] op_sel_hi:[1,0]
    v_pk_fma_f32 v[82:83], v[56:57], v[26:27], v[82:83] op_sel:[1,1,0] op_sel_hi:[0,1,1] neg_lo:[1,0,0]
    v_cvt_pk_bf16_f32 v104, v82, v83
    v_dot2_f32_bf16 v108, v104, s50, v82
    v_dot2_f32_bf16 v109, v104, s51, v83
    v_cvt_pk_bf16_f32 v81, v112, v113
    v_mov_b32 v82, v104
    v_pk_mul_f32 v[84:85], v[56:57], v[28:29] op_sel_hi:[1,0]
    v_pk_fma_f32 v[84:85], v[56:57], v[28:29], v[84:85] op_sel:[1,1,0] op_sel_hi:[0,1,1] neg_lo:[1,0,0]
    v_cvt_pk_bf16_f32 v105, v84, v85
    v_dot2_f32_bf16 v110, v105, s50, v84
    v_dot2_f32_bf16 v111, v105, s51, v85
    v_cvt_pk_bf16_f32 v83, v108, v109
    v_mov_b32 v84, v105
    v_pk_mul_f32 v[86:87], v[56:57], v[52:53] op_sel_hi:[1,0]
    v_pk_fma_f32 v[86:87], v[56:57], v[52:53], v[86:87] op_sel:[1,1,0] op_sel_hi:[0,1,1] neg_lo:[1,0,0]
    v_cvt_pk_bf16_f32 v106, v86, v87
    v_dot2_f32_bf16 v112, v106, s50, v86
    v_dot2_f32_bf16 v113, v106, s51, v87
    v_cvt_pk_bf16_f32 v85, v110, v111
    v_mov_b32 v86, v106
    v_cvt_pk_bf16_f32 v104, v42, v43
    v_dot2_f32_bf16 v108, v104, s50, v42
    v_dot2_f32_bf16 v109, v104, s51, v43
    v_cvt_pk_bf16_f32 v87, v112, v113
    v_mov_b32 v88, v104
    v_pk_mul_f32 v[90:91], v[42:43], v[28:29] op_sel_hi:[1,0]
    v_pk_fma_f32 v[90:91], v[42:43], v[28:29], v[90:91] op_sel:[1,1,0] op_sel_hi:[0,1,1] neg_lo:[1,0,0]
    v_cvt_pk_bf16_f32 v105, v90, v91
    v_dot2_f32_bf16 v110, v105, s50, v90
    v_dot2_f32_bf16 v111, v105, s51, v91
    v_cvt_pk_bf16_f32 v89, v108, v109
    v_mov_b32 v90, v105
    v_cvt_pk_bf16_f32 v106, v58, v59
    v_dot2_f32_bf16 v112, v106, s50, v58
    v_dot2_f32_bf16 v113, v106, s51, v59
    v_cvt_pk_bf16_f32 v91, v110, v111
    v_mov_b32 v92, v106
    v_pk_mul_f32 v[94:95], v[58:59], v[28:29] op_sel_hi:[1,0]
    v_pk_fma_f32 v[94:95], v[58:59], v[28:29], v[94:95] op_sel:[1,1,0] op_sel_hi:[0,1,1] neg_lo:[1,0,0]
    v_cvt_pk_bf16_f32 v104, v94, v95
    v_dot2_f32_bf16 v108, v104, s50, v94
    v_dot2_f32_bf16 v109, v104, s51, v95
    v_cvt_pk_bf16_f32 v93, v112, v113
    v_mov_b32 v94, v104
    v_cvt_pk_bf16_f32 v105, v60, v61
    v_dot2_f32_bf16 v110, v105, s50, v60
    v_dot2_f32_bf16 v111, v105, s51, v61
    v_cvt_pk_bf16_f32 v95, v108, v109
    v_mov_b32 v96, v105
    v_pk_mul_f32 v[98:99], v[60:61], v[28:29] op_sel_hi:[1,0]
    v_pk_fma_f32 v[98:99], v[60:61], v[28:29], v[98:99] op_sel:[1,1,0] op_sel_hi:[0,1,1] neg_lo:[1,0,0]
    v_cvt_pk_bf16_f32 v106, v98, v99
    v_dot2_f32_bf16 v112, v106, s50, v98
    v_dot2_f32_bf16 v113, v106, s51, v99
    v_cvt_pk_bf16_f32 v97, v110, v111
    v_mov_b32 v98, v106
    v_cvt_pk_bf16_f32 v104, v62, v63
    v_dot2_f32_bf16 v108, v104, s50, v62
    v_dot2_f32_bf16 v109, v104, s51, v63
    v_cvt_pk_bf16_f32 v99, v112, v113
    v_mov_b32 v100, v104
    v_pk_mul_f32 v[102:103], v[62:63], v[28:29] op_sel_hi:[1,0]
    v_pk_fma_f32 v[102:103], v[62:63], v[28:29], v[102:103] op_sel:[1,1,0] op_sel_hi:[0,1,1] neg_lo:[1,0,0]
    v_cvt_pk_bf16_f32 v105, v102, v103
    v_dot2_f32_bf16 v110, v105, s50, v102
    v_dot2_f32_bf16 v111, v105, s51, v103
    v_cvt_pk_bf16_f32 v101, v108, v109
    v_mov_b32 v102, v105
    s_nop 0
    v_cvt_pk_bf16_f32 v103, v110, v111
    s_waitcnt lgkmcnt(0)
    ds_read_b128 v[8:11], v6 offset:0
    ds_read_b128 v[12:15], v6 offset:256
    ds_read_b128 v[16:19], v6 offset:64
    ds_read_b128 v[20:23], v6 offset:320
    ds_read_b128 v[64:67], v6 offset:128
    ds_read_b128 v[68:71], v6 offset:384
    ds_read_b128 v[148:151], v6 offset:192
    ds_read_b128 v[152:155], v6 offset:448
    s_waitcnt lgkmcnt(0)
    v_mfma_f32_16x16x32_bf16 v[156:159], v[8:11], v[116:119], 0
    ds_write_addtid_b32 v72 offset:0
    ds_write_addtid_b32 v73 offset:256
    ds_write_addtid_b32 v74 offset:544
    v_mfma_f32_16x16x32_bf16 v[156:159], v[12:15], v[116:119], v[156:159]
    ds_write_addtid_b32 v75 offset:800
    ds_write_addtid_b32 v76 offset:1088
    ds_write_addtid_b32 v77 offset:1344
    v_mfma_f32_16x16x32_bf16 v[156:159], v[8:11], v[120:123], v[156:159]
    ds_write_addtid_b32 v78 offset:1632
    ds_write_addtid_b32 v79 offset:1888
    ds_write_addtid_b32 v80 offset:2176
    v_mfma_f32_16x16x32_bf16 v[156:159], v[16:19], v[124:127], v[156:159]
    ds_write_addtid_b32 v81 offset:2432
    ds_write_addtid_b32 v82 offset:2720
    ds_write_addtid_b32 v83 offset:2976
    v_mfma_f32_16x16x32_bf16 v[156:159], v[20:23], v[124:127], v[156:159]
    ds_write_addtid_b32 v84 offset:3264
    ds_write_addtid_b32 v85 offset:3520
    ds_write_addtid_b32 v86 offset:3808
    v_mfma_f32_16x16x32_bf16 v[156:159], v[16:19], v[128:131], v[156:159]
    ds_write_addtid_b32 v87 offset:4064
    ds_write_addtid_b32 v88 offset:4352
    ds_write_addtid_b32 v89 offset:4608
    v_mfma_f32_16x16x32_bf16 v[156:159], v[64:67], v[132:135], v[156:159]
    ds_write_addtid_b32 v90 offset:4896
    ds_write_addtid_b32 v91 offset:5152
    ds_write_addtid_b32 v92 offset:5440
    v_mfma_f32_16x16x32_bf16 v[156:159], v[68:71], v[132:135], v[156:159]
    ds_write_addtid_b32 v93 offset:5696
    ds_write_addtid_b32 v94 offset:5984
    ds_write_addtid_b32 v95 offset:6240
    v_mfma_f32_16x16x32_bf16 v[156:159], v[64:67], v[136:139], v[156:159]
    ds_write_addtid_b32 v96 offset:6528
    ds_write_addtid_b32 v97 offset:6784
    ds_write_addtid_b32 v98 offset:7072
    v_mfma_f32_16x16x32_bf16 v[156:159], v[148:151], v[140:143], v[156:159]
    ds_write_addtid_b32 v99 offset:7328
    ds_write_addtid_b32 v100 offset:7616
    ds_write_addtid_b32 v101 offset:7872
    v_mfma_f32_16x16x32_bf16 v[156:159], v[152:155], v[140:143], v[156:159]
    ds_write_addtid_b32 v102 offset:8160
    ds_write_addtid_b32 v103 offset:8416
    v_mfma_f32_16x16x32_bf16 v[156:159], v[148:151], v[144:147], v[156:159]
    v_cvt_pk_bf16_f32 v106, v44, v45
    v_dot2_f32_bf16 v112, v106, s50, v44
    v_dot2_f32_bf16 v113, v106, s51, v45
    v_mov_b32 v72, v106
    v_pk_mul_f32 v[74:75], v[44:45], v[38:39] op_sel_hi:[1,0]
    v_pk_fma_f32 v[74:75], v[44:45], v[38:39], v[74:75] op_sel:[1,1,0] op_sel_hi:[0,1,1] neg_lo:[1,0,0]
    v_cvt_pk_bf16_f32 v104, v74, v75
    v_dot2_f32_bf16 v108, v104, s50, v74
    v_dot2_f32_bf16 v109, v104, s51, v75
    v_cvt_pk_bf16_f32 v73, v112, v113
    v_mov_b32 v74, v104
    v_pk_mul_f32 v[76:77], v[44:45], v[40:41] op_sel_hi:[1,0]
    v_pk_fma_f32 v[76:77], v[44:45], v[40:41], v[76:77] op_sel:[1,1,0] op_sel_hi:[0,1,1] neg_lo:[1,0,0]
    v_cvt_pk_bf16_f32 v105, v76, v77
    v_dot2_f32_bf16 v110, v105, s50, v76
    v_dot2_f32_bf16 v111, v105, s51, v77
    v_cvt_pk_bf16_f32 v75, v108, v109
    v_mov_b32 v76, v105
    v_pk_mul_f32 v[78:79], v[44:45], v[56:57] op_sel_hi:[1,0]
    v_pk_fma_f32 v[78:79], v[44:45], v[56:57], v[78:79] op_sel:[1,1,0] op_sel_hi:[0,1,1] neg_lo:[1,0,0]
    v_cvt_pk_bf16_f32 v106, v78, v79
    v_dot2_f32_bf16 v112, v106, s50, v78
    v_dot2_f32_bf16 v113, v106, s51, v79
    v_cvt_pk_bf16_f32 v77, v110, v111
    v_mov_b32 v78, v106
    v_pk_mul_f32 v[80:81], v[44:45], v[42:43] op_sel_hi:[1,0]
    v_pk_fma_f32 v[80:81], v[44:45], v[42:43], v[80:81] op_sel:[1,1,0] op_sel_hi:[0,1,1] neg_lo:[1,0,0]
    v_cvt_pk_bf16_f32 v104, v80, v81
    v_dot2_f32_bf16 v108, v104, s50, v80
    v_dot2_f32_bf16 v109, v104, s51, v81
    v_cvt_pk_bf16_f32 v79, v112, v113
    v_mov_b32 v80, v104
    v_pk_mul_f32 v[82:83], v[44:45], v[58:59] op_sel_hi:[1,0]
    v_pk_fma_f32 v[82:83], v[44:45], v[58:59], v[82:83] op_sel:[1,1,0] op_sel_hi:[0,1,1] neg_lo:[1,0,0]
    v_cvt_pk_bf16_f32 v105, v82, v83
    v_dot2_f32_bf16 v110, v105, s50, v82
    v_dot2_f32_bf16 v111, v105, s51, v83
    v_cvt_pk_bf16_f32 v81, v108, v109
    v_mov_b32 v82, v105
    v_pk_mul_f32 v[84:85], v[44:45], v[60:61] op_sel_hi:[1,0]
    v_pk_fma_f32 v[84:85], v[44:45], v[60:61], v[84:85] op_sel:[1,1,0] op_sel_hi:[0,1,1] neg_lo:[1,0,0]
    v_cvt_pk_bf16_f32 v106, v84, v85
    v_dot2_f32_bf16 v112, v106, s50, v84
    v_dot2_f32_bf16 v113, v106, s51, v85
    v_cvt_pk_bf16_f32 v83, v110, v111
    v_mov_b32 v84, v106
    v_pk_mul_f32 v[86:87], v[44:45], v[62:63] op_sel_hi:[1,0]
    v_pk_fma_f32 v[86:87], v[44:45], v[62:63], v[86:87] op_sel:[1,1,0] op_sel_hi:[0,1,1] neg_lo:[1,0,0]
    v_cvt_pk_bf16_f32 v104, v86, v87
    v_dot2_f32_bf16 v108, v104, s50, v86
    v_dot2_f32_bf16 v109, v104, s51, v87
    v_cvt_pk_bf16_f32 v85, v112, v113
    v_mov_b32 v86, v104
    v_cvt_pk_bf16_f32 v105, v46, v47
    v_dot2_f32_bf16 v110, v105, s50, v46
    v_dot2_f32_bf16 v111, v105, s51, v47
    v_cvt_pk_bf16_f32 v87, v108, v109
    v_mov_b32 v88, v105
    s_nop 0
    v_cvt_pk_bf16_f32 v89, v110, v111
    s_waitcnt lgkmcnt(0)
    ds_read_b128 v[8:11], v6 offset:0
    ds_read_b128 v[12:15], v6 offset:256
    ds_read_b128 v[16:19], v6 offset:64
    ds_read_b128 v[20:23], v6 offset:320
    ds_read_b128 v[64:67], v6 offset:128
    ds_read_b128 v[68:71], v6 offset:384
    ds_read_b128 v[148:151], v6 offset:192
    ds_read_b128 v[152:155], v6 offset:448
    s_waitcnt lgkmcnt(0)
    v_mfma_f32_16x16x32_bf16 v[160:163], v[8:11], v[116:119], 0
    ds_write_addtid_b32 v72 offset:0
    ds_write_addtid_b32 v73 offset:256
    ds_write_addtid_b32 v74 offset:544
    v_mfma_f32_16x16x32_bf16 v[160:163], v[12:15], v[116:119], v[160:163]
    ds_write_addtid_b32 v75 offset:800
    ds_write_addtid_b32 v76 offset:1088
    ds_write_addtid_b32 v77 offset:1344
    v_mfma_f32_16x16x32_bf16 v[160:163], v[8:11], v[120:123], v[160:163]
    ds_write_addtid_b32 v78 offset:1632
    ds_write_addtid_b32 v79 offset:1888
    ds_write_addtid_b32 v80 offset:2176
    v_mfma_f32_16x16x32_bf16 v[160:163], v[16:19], v[124:127], v[160:163]
    ds_write_addtid_b32 v81 offset:2432
    ds_write_addtid_b32 v82 offset:2720
    ds_write_addtid_b32 v83 offset:2976
    v_mfma_f32_16x16x32_bf16 v[160:163], v[20:23], v[124:127], v[160:163]
    ds_write_addtid_b32 v84 offset:3264
    ds_write_addtid_b32 v85 offset:3520
    ds_write_addtid_b32 v86 offset:3808
    v_mfma_f32_16x16x32_bf16 v[160:163], v[16:19], v[128:131], v[160:163]
    ds_write_addtid_b32 v87 offset:4064
    ds_write_addtid_b32 v88 offset:4352
    ds_write_addtid_b32 v89 offset:4608
    v_mfma_f32_16x16x32_bf16 v[160:163], v[64:67], v[132:135], v[160:163]
    v_mfma_f32_16x16x32_bf16 v[160:163], v[68:71], v[132:135], v[160:163]
    v_mfma_f32_16x16x32_bf16 v[160:163], v[64:67], v[136:139], v[160:163]
    v_mfma_f32_16x16x32_bf16 v[160:163], v[148:151], v[140:143], v[160:163]
    v_mfma_f32_16x16x32_bf16 v[160:163], v[152:155], v[140:143], v[160:163]
    v_mfma_f32_16x16x32_bf16 v[160:163], v[148:151], v[144:147], v[160:163]
    s_waitcnt lgkmcnt(0)
    ds_read_b128 v[8:11], v6 offset:0
    ds_read_b128 v[12:15], v6 offset:256
    ds_read_b128 v[16:19], v6 offset:64
    ds_read_b128 v[20:23], v6 offset:320
    ds_read_b128 v[64:67], v6 offset:128
    ds_read_b128 v[68:71], v6 offset:384
    ds_read_b128 v[148:151], v6 offset:192
    ds_read_b128 v[152:155], v6 offset:448
    s_waitcnt lgkmcnt(0)
    v_mfma_f32_16x16x32_bf16 v[164:167], v[8:11], v[116:119], 0
    v_mfma_f32_16x16x32_bf16 v[164:167], v[12:15], v[116:119], v[164:167]
    v_mfma_f32_16x16x32_bf16 v[164:167], v[8:11], v[120:123], v[164:167]
    v_mfma_f32_16x16x32_bf16 v[164:167], v[16:19], v[124:127], v[164:167]
    v_mfma_f32_16x16x32_bf16 v[164:167], v[20:23], v[124:127], v[164:167]
    v_mfma_f32_16x16x32_bf16 v[164:167], v[16:19], v[128:131], v[164:167]
    v_mfma_f32_16x16x32_bf16 v[164:167], v[64:67], v[132:135], v[164:167]
    v_mfma_f32_16x16x32_bf16 v[164:167], v[68:71], v[132:135], v[164:167]
    v_mfma_f32_16x16x32_bf16 v[164:167], v[64:67], v[136:139], v[164:167]
    v_mfma_f32_16x16x32_bf16 v[164:167], v[148:151], v[140:143], v[164:167]
    v_mfma_f32_16x16x32_bf16 v[164:167], v[152:155], v[140:143], v[164:167]
    v_mfma_f32_16x16x32_bf16 v[164:167], v[148:151], v[144:147], v[164:167]
    s_lshl_b32 s20, s2, 13
    s_lshr_b32 s21, s2, 2
    s_lshl_b32 s21, s21, 15
    s_add_u32 s8, s4, s21
    s_addc_u32 s9, s5, 0
    s_add_u32 s8, s8, 2097152
    s_addc_u32 s9, s9, 0
    s_mov_b32 s10, 32768
    s_mov_b32 s11, 0x00020000
    s_and_b32 s21, s2, 3
    s_lshl_b32 s21, s21, 2
    s_add_u32 s16, s4, s20
    s_addc_u32 s17, s5, 0
    s_add_u32 s16, s16, 4194304
    s_addc_u32 s17, s17, 0
    s_mov_b32 s18, 8192
    s_mov_b32 s19, 0x00020000
    s_add_u32 s36, s4, 1835008
    s_addc_u32 s37, s5, 0
    s_mov_b32 s38, 43008
    s_mov_b32 s39, 0x00020000
    s_add_u32 s40, s4, 0
    s_addc_u32 s41, s5, 0
    s_mov_b32 s42, 5376
    s_mov_b32 s43, 0x00020000
    v_lshlrev_b32 v5, 4, v0
    v_add_u32 v5, 93184, v5
    ds_read_b128 v[80:83], v5
    ds_read_b128 v[84:87], v5 offset:8192
    ds_read_b128 v[88:91], v5 offset:16384
    ds_read_b128 v[92:95], v5 offset:24576
    ds_read_b128 v[96:99], v5 offset:32768
    v_and_b32 v5, 255, v0
    v_lshrrev_b32 v6, 8, v0
    v_lshlrev_b32 v10, 4, v1
    v_add_u32 v10, s60, v10
    ds_write_b128 v10, v[156:159]
    ds_write_b128 v10, v[160:163] offset:1024
    ds_write_b128 v10, v[164:167] offset:2048
    s_waitcnt lgkmcnt(0)
    v_mov_b32 v13, v88
    v_mov_b32 v14, v89
    v_mov_b32 v40, v90
    v_mov_b32 v148, v91
    v_mov_b32 v149, v92
    v_mov_b32 v150, v93
    s_barrier
    s_and_b32 s61, s3, 3
    s_cmp_lg_u32 s61, 3
    s_cbranch_scc1 KA_red
    s_cmp_lg_u32 s3, 3
    s_cbranch_scc1 KA_bar2
    s_add_u32 s44, s4, 1966080
    s_addc_u32 s45, s5, 0
    s_mov_b32 s46, 8192
    s_mov_b32 s47, 0x00020000
    v_mov_b32 v11, 93008
    ds_read_b128 v[48:51], v11
    s_and_b32 s29, s90, 31
    s_lshl_b32 s29, s29, 8
    v_mov_b32 v56, 0
    s_mov_b32 s28, 0
    s_mov_b64 exec, 1
    s_waitcnt lgkmcnt(0)
KA_poll2:
    buffer_load_dwordx4 v[52:55], v56, s[44:47], s29 offen sc1
    s_add_u32 s28, s28, 1
    s_waitcnt vmcnt(0)
    v_cmp_eq_u32 s[30:31], v48, v52
    v_cmp_eq_u32 s[32:33], v49, v53
    v_cmp_eq_u32 s[34:35], v50, v54
    v_cmp_eq_u32 vcc, v51, v55
    s_or_b64 s[30:31], s[30:31], s[32:33]
    s_or_b64 s[34:35], s[34:35], vcc
    s_or_b64 s[30:31], s[30:31], s[34:35]
    s_cbranch_scc0 KA_pdone
    s_cmp_ge_u32 s28, 400000
    s_cbranch_scc1 KA_pdone
    s_sleep 2
    s_branch KA_poll2
KA_pdone:
    s_mov_b64 exec, -1
    s_branch KA_bar2
KA_red:
    s_lshr_b32 s57, s3, 2
    s_mul_i32 s56, s57, 34816
    s_lshl_b32 s58, s61, 10
    s_add_u32 s56, s56, s58
    v_lshlrev_b32 v10, 4, v1
    v_add_u32 v10, s56, v10
    ds_read_b128 v[48:51], v10
    ds_read_b128 v[52:55], v10 offset:8704
    ds_read_b128 v[56:59], v10 offset:17408
    ds_read_b128 v[60:63], v10 offset:26112
    s_waitcnt lgkmcnt(0)
    v_add_f32 v48, v48, v52
    v_add_f32 v56, v56, v60
    v_add_f32 v48, v48, v56
    ds_write_b32 v96, v48
    v_add_f32 v49, v49, v53
    v_add_f32 v57, v57, v61
    v_add_f32 v49, v49, v57
    ds_write_b32 v97, v49
    v_add_f32 v50, v50, v54
    v_add_f32 v58, v58, v62
    v_add_f32 v50, v50, v58
    ds_write_b32 v98, v50
    v_add_f32 v51, v51, v55
    v_add_f32 v59, v59, v63
    v_add_f32 v51, v51, v59
    ds_write_b32 v99, v51
KA_bar2:
    s_waitcnt lgkmcnt(0)
    s_barrier
    buffer_load_dword v16, v40, s[8:11], 0 offen sc1
    s_movk_i32 s23, 8192
    buffer_load_dword v17, v40, s[8:11], s23 offen sc1
    s_movk_i32 s23, 16384
    buffer_load_dword v18, v40, s[8:11], s23 offen sc1
    s_movk_i32 s23, 24576
    buffer_load_dword v19, v40, s[8:11], s23 offen sc1
    buffer_load_dword v152, v14, s[36:39], 0 offen sc1
    s_movk_i32 s23, 10752
    buffer_load_dword v153, v14, s[36:39], s23 offen sc1
    s_movk_i32 s23, 21504
    buffer_load_dword v154, v14, s[36:39], s23 offen sc1
    s_mov_b32 s23, 32256
    buffer_load_dword v155, v14, s[36:39], s23 offen sc1
    ds_read_b32 v28, v80
    ds_read_b32 v29, v81
    ds_read_b32 v30, v82
    ds_read_b32 v31, v83
    ds_read_b32 v32, v84
    ds_read_b32 v33, v85
    ds_read_b32 v34, v86
    ds_read_b32 v35, v87
    v_mov_b32 v36, 0
    v_mov_b32 v37, 0
    v_mov_b32 v38, 0
    v_mov_b32 v39, 0
    v_lshrrev_b32 v9, 4, v0
    v_mul_u32_u24 v9, 4384, v9
    v_and_b32 v10, 15, v0
    v_lshl_add_u32 v9, v10, 4, v9
    v_cmp_gt_u32 vcc, 256, v0
    s_nop 0
    s_and_saveexec_b64 s[32:33], vcc
    ds_write_b128 v9, v[36:39] offset:4096
    s_mov_b64 exec, s[32:33]
    v_mul_u32_u24 v9, 8704, v6
    v_lshl_add_u32 v9, v5, 4, v9
    v_add_u32 v9, 70144, v9
    v_cmp_gt_u32 vcc, 15, v5
    s_nop 0
    s_and_saveexec_b64 s[32:33], vcc
    ds_write_b128 v9, v[36:39]
    ds_write_b128 v9, v[36:39] offset:4352
    s_mov_b64 exec, s[32:33]
    s_waitcnt lgkmcnt(0)
    v_cvt_pk_bf16_f32 v112, v28, v29
    v_lshlrev_b32 v120, 16, v112
    v_and_b32 v121, 0xffff0000, v112
    v_sub_f32 v28, v28, v120
    v_sub_f32 v29, v29, v121
    v_cvt_pk_bf16_f32 v116, v28, v29
    v_cvt_pk_bf16_f32 v113, v30, v31
    v_lshlrev_b32 v120, 16, v113
    v_and_b32 v121, 0xffff0000, v113
    v_sub_f32 v30, v30, v120
    v_sub_f32 v31, v31, v121
    v_cvt_pk_bf16_f32 v117, v30, v31
    v_cvt_pk_bf16_f32 v114, v32, v33
    v_lshlrev_b32 v120, 16, v114
    v_and_b32 v121, 0xffff0000, v114
    v_sub_f32 v32, v32, v120
    v_sub_f32 v33, v33, v121
    v_cvt_pk_bf16_f32 v118, v32, v33
    v_cvt_pk_bf16_f32 v115, v34, v35
    v_lshlrev_b32 v120, 16, v115
    v_and_b32 v121, 0xffff0000, v115
    v_sub_f32 v34, v34, v120
    v_sub_f32 v35, v35, v121
    v_cvt_pk_bf16_f32 v119, v34, v35
    ds_write_b128 v9, v[112:115] offset:240
    ds_write_b128 v9, v[116:119] offset:4592
    s_waitcnt vmcnt(0)
    v_add_f32 v152, v152, v153
    v_add_f32 v154, v154, v155
    v_add_f32 v152, v152, v154
    v_cvt_pk_bf16_f32 v152, v152, v152
    buffer_store_short v152, v13, s[40:43], 0 offen sc1
    v_and_b32 v152, 0xffff0000, v152
    s_nop 0
    v_readlane_b32 s28, v152, 0
    v_readlane_b32 s31, v152, 1
    v_readlane_b32 s29, v152, 2
    v_readlane_b32 s34, v152, 3
    v_mov_b32 v42, s28
    v_mov_b32 v43, s31
    v_add_f32 v40, 1.0, s29
    v_add_f32 v41, 1.0, s34
    v_cvt_pk_bf16_f32 v40, v40, v41
    v_and_b32 v41, 0xffff0000, v40
    v_lshlrev_b32 v40, 16, v40
    s_lshl_b32 s31, s59, 16
    s_and_b32 s30, s59, 0xffff0000
    v_mov_b32 v48, s31
    v_mov_b32 v49, s30
    v_lshlrev_b32 v9, 1, v0
    v_sub_u32 v9, 1022, v9
    v_lshlrev_b32 v52, 16, v16
    v_and_b32 v53, 0xffff0000, v16
    v_mul_f32 v52, v52, v40
    v_mul_f32 v53, v53, v41
    v_cvt_pk_bf16_f32 v52, v52, v53
    v_and_b32 v53, 0xffff0000, v52
    v_lshlrev_b32 v52, 16, v52
    v_add_f32 v52, v52, v42
    v_add_f32 v53, v53, v43
    v_cvt_pk_bf16_f32 v52, v52, v53
    ds_write_b16 v9, v52 offset:3072
    ds_write_b16_d16_hi v9, v52 offset:38144
    v_lshlrev_b32 v54, 16, v17
    v_and_b32 v55, 0xffff0000, v17
    v_mul_f32 v54, v54, v40
    v_mul_f32 v55, v55, v41
    v_cvt_pk_bf16_f32 v54, v54, v55
    v_and_b32 v55, 0xffff0000, v54
    v_lshlrev_b32 v54, 16, v54
    v_add_f32 v54, v54, v42
    v_add_f32 v55, v55, v43
    v_cvt_pk_bf16_f32 v54, v54, v55
    ds_write_b16 v9, v54 offset:2048
    ds_write_b16_d16_hi v9, v54 offset:37120
    v_lshlrev_b32 v56, 16, v18
    v_and_b32 v57, 0xffff0000, v18
    v_mul_f32 v56, v56, v40
    v_mul_f32 v57, v57, v41
    v_cvt_pk_bf16_f32 v56, v56, v57
    v_and_b32 v57, 0xffff0000, v56
    v_lshlrev_b32 v56, 16, v56
    v_add_f32 v56, v56, v42
    v_add_f32 v57, v57, v43
    v_cvt_pk_bf16_f32 v56, v56, v57
    ds_write_b16 v9, v56 offset:1024
    ds_write_b16_d16_hi v9, v56 offset:36096
    v_lshlrev_b32 v58, 16, v19
    v_and_b32 v59, 0xffff0000, v19
    v_mul_f32 v58, v58, v40
    v_mul_f32 v59, v59, v41
    v_cvt_pk_bf16_f32 v58, v58, v59
    v_and_b32 v59, 0xffff0000, v58
    v_lshlrev_b32 v58, 16, v58
    v_add_f32 v58, v58, v42
    v_add_f32 v59, v59, v43
    v_cvt_pk_bf16_f32 v58, v58, v59
    ds_write_b16 v9, v58 offset:0
    ds_write_b16_d16_hi v9, v58 offset:35072
    v_lshlrev_b32 v10, 3, v0
    v_sub_u32 v10, 4088, v10
    v_and_b32 v9, 1, v0
    v_sub_u32 v9, 1, v9
    v_mul_u32_u24 v9, 17536, v9
    v_lshrrev_b32 v11, 1, v0
    v_sub_u32 v11, 255, v11
    v_lshl_add_u32 v9, v11, 4, v9
    s_waitcnt lgkmcnt(0)
    s_barrier
    ds_read_b64 v[52:53], v10 offset:0
    ds_read_b64 v[54:55], v10 offset:8
    ds_read_b64 v[56:57], v10 offset:16
    ds_read_b64 v[60:61], v10 offset:35072
    ds_read_b64 v[62:63], v10 offset:35080
    ds_read_b64 v[64:65], v10 offset:35088
    s_waitcnt lgkmcnt(3)
    v_alignbit_b32 v84, v53, v52, 16
    v_alignbit_b32 v85, v54, v53, 16
    v_alignbit_b32 v86, v55, v54, 16
    v_alignbit_b32 v87, v56, v55, 16
    v_mov_b32 v88, v53
    v_mov_b32 v89, v54
    v_mov_b32 v90, v55
    v_mov_b32 v91, v56
    v_alignbit_b32 v92, v54, v53, 16
    v_alignbit_b32 v93, v55, v54, 16
    v_alignbit_b32 v94, v56, v55, 16
    v_alignbit_b32 v95, v57, v56, 16
    s_waitcnt lgkmcnt(0)
    v_alignbit_b32 v100, v61, v60, 16
    v_alignbit_b32 v101, v62, v61, 16
    v_alignbit_b32 v102, v63, v62, 16
    v_alignbit_b32 v103, v64, v63, 16
    v_mov_b32 v104, v61
    v_mov_b32 v105, v62
    v_mov_b32 v106, v63
    v_mov_b32 v107, v64
    v_alignbit_b32 v108, v62, v61, 16
    v_alignbit_b32 v109, v63, v62, 16
    v_alignbit_b32 v110, v64, v63, 16
    v_alignbit_b32 v111, v65, v64, 16
    ds_write_b128 v9, v[52:55] offset:0
    ds_write_b128 v9, v[84:87] offset:4384
    ds_write_b128 v9, v[88:91] offset:8768
    ds_write_b128 v9, v[92:95] offset:13152
    ds_write_b128 v9, v[60:63] offset:35072
    ds_write_b128 v9, v[100:103] offset:39456
    ds_write_b128 v9, v[104:107] offset:43840
    ds_write_b128 v9, v[108:111] offset:48224
    v_mov_b32 v160, v52
    v_mov_b32 v161, v53
    v_mov_b32 v162, v60
    v_mov_b32 v163, v61
    v_mov_b32 v164, v48
    v_mov_b32 v165, v49
    s_waitcnt lgkmcnt(0)
    s_barrier
    ds_read_b128 v[80:83], v149 offset:0
    ds_read_b128 v[84:87], v149 offset:4352
    ds_read_b128 v[16:19], v148 offset:3584
    ds_read_b128 v[20:23], v148 offset:3072
    ds_read_b128 v[24:27], v148 offset:2560
    ds_read_b128 v[28:31], v148 offset:2048
    ds_read_b128 v[32:35], v148 offset:1536
    ds_read_b128 v[36:39], v148 offset:1024
    ds_read_b128 v[40:43], v148 offset:512
    ds_read_b128 v[44:47], v148 offset:0
    ds_read_b128 v[88:91], v149 offset:512
    ds_read_b128 v[92:95], v149 offset:4864
    ds_read_b128 v[96:99], v149 offset:1024
    ds_read_b128 v[100:103], v149 offset:5376
    ds_read_b128 v[48:51], v148 offset:3648
    s_waitcnt lgkmcnt(14)
    s_waitcnt lgkmcnt(12)
    v_mfma_f32_16x16x32_bf16 v[112:115], v[16:19], v[80:83], 0
    s_waitcnt lgkmcnt(11)
    v_mfma_f32_16x16x32_bf16 v[116:119], v[20:23], v[80:83], 0
    s_waitcnt lgkmcnt(10)
    v_mfma_f32_16x16x32_bf16 v[120:123], v[24:27], v[80:83], 0
    s_waitcnt lgkmcnt(9)
    v_mfma_f32_16x16x32_bf16 v[124:127], v[28:31], v[80:83], 0
    s_waitcnt lgkmcnt(8)
    v_mfma_f32_16x16x32_bf16 v[128:131], v[32:35], v[80:83], 0
    s_waitcnt lgkmcnt(7)
    v_mfma_f32_16x16x32_bf16 v[132:135], v[36:39], v[80:83], 0
    s_waitcnt lgkmcnt(6)
    v_mfma_f32_16x16x32_bf16 v[136:139], v[40:43], v[80:83], 0
    s_waitcnt lgkmcnt(5)
    v_mfma_f32_16x16x32_bf16 v[140:143], v[44:47], v[80:83], 0
    v_mfma_f32_16x16x32_bf16 v[112:115], v[16:19], v[84:87], v[112:115]
    v_mfma_f32_16x16x32_bf16 v[116:119], v[20:23], v[84:87], v[116:119]
    v_mfma_f32_16x16x32_bf16 v[120:123], v[24:27], v[84:87], v[120:123]
    v_mfma_f32_16x16x32_bf16 v[124:127], v[28:31], v[84:87], v[124:127]
    v_mfma_f32_16x16x32_bf16 v[128:131], v[32:35], v[84:87], v[128:131]
    v_mfma_f32_16x16x32_bf16 v[132:135], v[36:39], v[84:87], v[132:135]
    v_mfma_f32_16x16x32_bf16 v[136:139], v[40:43], v[84:87], v[136:139]
    v_mfma_f32_16x16x32_bf16 v[140:143], v[44:47], v[84:87], v[140:143]
    ds_read_b128 v[80:83], v149 offset:1536
    ds_read_b128 v[84:87], v149 offset:5888
    ds_read_b128 v[52:55], v148 offset:3136
    s_waitcnt lgkmcnt(7)
    v_mfma_f32_16x16x32_bf16 v[116:119], v[16:19], v[88:91], v[116:119]
    v_mfma_f32_16x16x32_bf16 v[120:123], v[20:23], v[88:91], v[120:123]
    v_mfma_f32_16x16x32_bf16 v[124:127], v[24:27], v[88:91], v[124:127]
    v_mfma_f32_16x16x32_bf16 v[128:131], v[28:31], v[88:91], v[128:131]
    v_mfma_f32_16x16x32_bf16 v[132:135], v[32:35], v[88:91], v[132:135]
    v_mfma_f32_16x16x32_bf16 v[136:139], v[36:39], v[88:91], v[136:139]
    v_mfma_f32_16x16x32_bf16 v[140:143], v[40:43], v[88:91], v[140:143]
    s_waitcnt lgkmcnt(6)
    v_mfma_f32_16x16x32_bf16 v[116:119], v[16:19], v[92:95], v[116:119]
    v_mfma_f32_16x16x32_bf16 v[120:123], v[20:23], v[92:95], v[120:123]
    v_mfma_f32_16x16x32_bf16 v[124:127], v[24:27], v[92:95], v[124:127]
    v_mfma_f32_16x16x32_bf16 v[128:131], v[28:31], v[92:95], v[128:131]
    v_mfma_f32_16x16x32_bf16 v[132:135], v[32:35], v[92:95], v[132:135]
    v_mfma_f32_16x16x32_bf16 v[136:139], v[36:39], v[92:95], v[136:139]
    v_mfma_f32_16x16x32_bf16 v[140:143], v[40:43], v[92:95], v[140:143]
    v_and_b32 v152, 0xffff0000, v161
    v_and_b32 v153, 0xffff0000, v163
    v_mul_f32 v152, v152, v164
    v_mul_f32 v153, v153, v165
    v_cvt_pk_bf16_f32 v152, v152, v153
    v_and_b32 v153, 0xffff0000, v152
    v_lshlrev_b32 v152, 16, v152
    v_lshlrev_b32 v154, 16, v161
    v_lshlrev_b32 v155, 16, v163
    v_mul_f32 v154, v154, v164
    v_mul_f32 v155, v155, v165
    v_cvt_pk_bf16_f32 v154, v154, v155
    v_and_b32 v155, 0xffff0000, v154
    v_lshlrev_b32 v154, 16, v154
    v_and_b32 v156, 0xffff0000, v160
    v_and_b32 v157, 0xffff0000, v162
    v_mul_f32 v156, v156, v164
    v_mul_f32 v157, v157, v165
    v_cvt_pk_bf16_f32 v156, v156, v157
    v_and_b32 v157, 0xffff0000, v156
    v_lshlrev_b32 v156, 16, v156
    v_lshlrev_b32 v158, 16, v160
    v_lshlrev_b32 v159, 16, v162
    v_mul_f32 v158, v158, v164
    v_mul_f32 v159, v159, v165
    v_cvt_pk_bf16_f32 v158, v158, v159
    v_and_b32 v159, 0xffff0000, v158
    v_lshlrev_b32 v158, 16, v158
    ds_read_b128 v[88:91], v149 offset:2048
    ds_read_b128 v[92:95], v149 offset:6400
    ds_read_b128 v[56:59], v148 offset:2624
    s_waitcnt lgkmcnt(8)
    v_mfma_f32_16x16x32_bf16 v[120:123], v[16:19], v[96:99], v[120:123]
    v_mfma_f32_16x16x32_bf16 v[124:127], v[20:23], v[96:99], v[124:127]
    v_mfma_f32_16x16x32_bf16 v[128:131], v[24:27], v[96:99], v[128:131]
    v_mfma_f32_16x16x32_bf16 v[132:135], v[28:31], v[96:99], v[132:135]
    v_mfma_f32_16x16x32_bf16 v[136:139], v[32:35], v[96:99], v[136:139]
    v_mfma_f32_16x16x32_bf16 v[140:143], v[36:39], v[96:99], v[140:143]
    s_waitcnt lgkmcnt(7)
    v_mfma_f32_16x16x32_bf16 v[120:123], v[16:19], v[100:103], v[120:123]
    v_mfma_f32_16x16x32_bf16 v[124:127], v[20:23], v[100:103], v[124:127]
    v_mfma_f32_16x16x32_bf16 v[128:131], v[24:27], v[100:103], v[128:131]
    v_mfma_f32_16x16x32_bf16 v[132:135], v[28:31], v[100:103], v[132:135]
    v_mfma_f32_16x16x32_bf16 v[136:139], v[32:35], v[100:103], v[136:139]
    v_mfma_f32_16x16x32_bf16 v[140:143], v[36:39], v[100:103], v[140:143]
    ds_read_b128 v[96:99], v149 offset:2560
    ds_read_b128 v[100:103], v149 offset:6912
    ds_read_b128 v[60:63], v148 offset:2112
    s_waitcnt lgkmcnt(8)
    v_mfma_f32_16x16x32_bf16 v[124:127], v[16:19], v[80:83], v[124:127]
    v_mfma_f32_16x16x32_bf16 v[128:131], v[20:23], v[80:83], v[128:131]
    v_mfma_f32_16x16x32_bf16 v[132:135], v[24:27], v[80:83], v[132:135]
    v_mfma_f32_16x16x32_bf16 v[136:139], v[28:31], v[80:83], v[136:139]
    v_mfma_f32_16x16x32_bf16 v[140:143], v[32:35], v[80:83], v[140:143]
    s_waitcnt lgkmcnt(7)
    v_mfma_f32_16x16x32_bf16 v[124:127], v[16:19], v[84:87], v[124:127]
    v_mfma_f32_16x16x32_bf16 v[128:131], v[20:23], v[84:87], v[128:131]
    v_mfma_f32_16x16x32_bf16 v[132:135], v[24:27], v[84:87], v[132:135]
    v_mfma_f32_16x16x32_bf16 v[136:139], v[28:31], v[84:87], v[136:139]
    v_mfma_f32_16x16x32_bf16 v[140:143], v[32:35], v[84:87], v[140:143]
    ds_read_b128 v[80:83], v149 offset:3072
    ds_read_b128 v[84:87], v149 offset:7424
    ds_read_b128 v[64:67], v148 offset:1600
    s_waitcnt lgkmcnt(8)
    v_mfma_f32_16x16x32_bf16 v[128:131], v[16:19], v[88:91], v[128:131]
    v_mfma_f32_16x16x32_bf16 v[132:135], v[20:23], v[88:91], v[132:135]
    v_mfma_f32_16x16x32_bf16 v[136:139], v[24:27], v[88:91], v[136:139]
    v_mfma_f32_16x16x32_bf16 v[140:143], v[28:31], v[88:91], v[140:143]
    s_waitcnt lgkmcnt(7)
    v_mfma_f32_16x16x32_bf16 v[128:131], v[16:19], v[92:95], v[128:131]
    v_mfma_f32_16x16x32_bf16 v[132:135], v[20:23], v[92:95], v[132:135]
    v_mfma_f32_16x16x32_bf16 v[136:139], v[24:27], v[92:95], v[136:139]
    v_mfma_f32_16x16x32_bf16 v[140:143], v[28:31], v[92:95], v[140:143]
    ds_read_b128 v[88:91], v149 offset:3584
    ds_read_b128 v[92:95], v149 offset:7936
    ds_read_b128 v[68:71], v148 offset:1088
    s_waitcnt lgkmcnt(8)
    v_mfma_f32_16x16x32_bf16 v[132:135], v[16:19], v[96:99], v[132:135]
    v_mfma_f32_16x16x32_bf16 v[136:139], v[20:23], v[96:99], v[136:139]
    v_mfma_f32_16x16x32_bf16 v[140:143], v[24:27], v[96:99], v[140:143]
    s_waitcnt lgkmcnt(7)
    v_mfma_f32_16x16x32_bf16 v[132:135], v[16:19], v[100:103], v[132:135]
    v_mfma_f32_16x16x32_bf16 v[136:139], v[20:23], v[100:103], v[136:139]
    v_mfma_f32_16x16x32_bf16 v[140:143], v[24:27], v[100:103], v[140:143]
    ds_read_b128 v[96:99], v149 offset:64
    ds_read_b128 v[100:103], v149 offset:4416
    ds_read_b128 v[72:75], v148 offset:576
    s_waitcnt lgkmcnt(8)
    v_mfma_f32_16x16x32_bf16 v[136:139], v[16:19], v[80:83], v[136:139]
    v_mfma_f32_16x16x32_bf16 v[140:143], v[20:23], v[80:83], v[140:143]
    s_waitcnt lgkmcnt(7)
    v_mfma_f32_16x16x32_bf16 v[136:139], v[16:19], v[84:87], v[136:139]
    v_mfma_f32_16x16x32_bf16 v[140:143], v[20:23], v[84:87], v[140:143]
    ds_read_b128 v[80:83], v149 offset:576
    ds_read_b128 v[84:87], v149 offset:4928
    ds_read_b128 v[76:79], v148 offset:64
    s_waitcnt lgkmcnt(8)
    v_mfma_f32_16x16x32_bf16 v[140:143], v[16:19], v[88:91], v[140:143]
    s_waitcnt lgkmcnt(7)
    v_mfma_f32_16x16x32_bf16 v[140:143], v[16:19], v[92:95], v[140:143]
    ds_read_b128 v[88:91], v149 offset:1088
    ds_read_b128 v[92:95], v149 offset:5440
    s_waitcnt lgkmcnt(7)
    v_mfma_f32_16x16x32_bf16 v[112:115], v[48:51], v[96:99], v[112:115]
    v_mfma_f32_16x16x32_bf16 v[116:119], v[52:55], v[96:99], v[116:119]
    v_mfma_f32_16x16x32_bf16 v[120:123], v[56:59], v[96:99], v[120:123]
    v_mfma_f32_16x16x32_bf16 v[124:127], v[60:63], v[96:99], v[124:127]
    v_mfma_f32_16x16x32_bf16 v[128:131], v[64:67], v[96:99], v[128:131]
    v_mfma_f32_16x16x32_bf16 v[132:135], v[68:71], v[96:99], v[132:135]
    s_waitcnt lgkmcnt(5)
    v_mfma_f32_16x16x32_bf16 v[136:139], v[72:75], v[96:99], v[136:139]
    s_waitcnt lgkmcnt(2)
    v_mfma_f32_16x16x32_bf16 v[140:143], v[76:79], v[96:99], v[140:143]
    v_mfma_f32_16x16x32_bf16 v[112:115], v[48:51], v[100:103], v[112:115]
    v_mfma_f32_16x16x32_bf16 v[116:119], v[52:55], v[100:103], v[116:119]
    v_mfma_f32_16x16x32_bf16 v[120:123], v[56:59], v[100:103], v[120:123]
    v_mfma_f32_16x16x32_bf16 v[124:127], v[60:63], v[100:103], v[124:127]
    v_mfma_f32_16x16x32_bf16 v[128:131], v[64:67], v[100:103], v[128:131]
    v_mfma_f32_16x16x32_bf16 v[132:135], v[68:71], v[100:103], v[132:135]
    v_mfma_f32_16x16x32_bf16 v[136:139], v[72:75], v[100:103], v[136:139]
    v_mfma_f32_16x16x32_bf16 v[140:143], v[76:79], v[100:103], v[140:143]
    ds_read_b128 v[96:99], v149 offset:1600
    ds_read_b128 v[100:103], v149 offset:5952
    v_mfma_f32_16x16x32_bf16 v[116:119], v[48:51], v[80:83], v[116:119]
    v_mfma_f32_16x16x32_bf16 v[120:123], v[52:55], v[80:83], v[120:123]
    v_mfma_f32_16x16x32_bf16 v[124:127], v[56:59], v[80:83], v[124:127]
    v_mfma_f32_16x16x32_bf16 v[128:131], v[60:63], v[80:83], v[128:131]
    v_mfma_f32_16x16x32_bf16 v[132:135], v[64:67], v[80:83], v[132:135]
    v_mfma_f32_16x16x32_bf16 v[136:139], v[68:71], v[80:83], v[136:139]
    v_mfma_f32_16x16x32_bf16 v[140:143], v[72:75], v[80:83], v[140:143]
    v_mfma_f32_16x16x32_bf16 v[116:119], v[48:51], v[84:87], v[116:119]
    v_mfma_f32_16x16x32_bf16 v[120:123], v[52:55], v[84:87], v[120:123]
    v_mfma_f32_16x16x32_bf16 v[124:127], v[56:59], v[84:87], v[124:127]
    v_mfma_f32_16x16x32_bf16 v[128:131], v[60:63], v[84:87], v[128:131]
    v_mfma_f32_16x16x32_bf16 v[132:135], v[64:67], v[84:87], v[132:135]
    v_mfma_f32_16x16x32_bf16 v[136:139], v[68:71], v[84:87], v[136:139]
    v_mfma_f32_16x16x32_bf16 v[140:143], v[72:75], v[84:87], v[140:143]
    ds_read_b128 v[80:83], v149 offset:2112
    ds_read_b128 v[84:87], v149 offset:6464
    s_waitcnt lgkmcnt(5)
    v_mfma_f32_16x16x32_bf16 v[120:123], v[48:51], v[88:91], v[120:123]
    v_mfma_f32_16x16x32_bf16 v[124:127], v[52:55], v[88:91], v[124:127]
    v_mfma_f32_16x16x32_bf16 v[128:131], v[56:59], v[88:91], v[128:131]
    v_mfma_f32_16x16x32_bf16 v[132:135], v[60:63], v[88:91], v[132:135]
    v_mfma_f32_16x16x32_bf16 v[136:139], v[64:67], v[88:91], v[136:139]
    v_mfma_f32_16x16x32_bf16 v[140:143], v[68:71], v[88:91], v[140:143]
    s_waitcnt lgkmcnt(4)
    v_mfma_f32_16x16x32_bf16 v[120:123], v[48:51], v[92:95], v[120:123]
    v_mfma_f32_16x16x32_bf16 v[124:127], v[52:55], v[92:95], v[124:127]
    v_mfma_f32_16x16x32_bf16 v[128:131], v[56:59], v[92:95], v[128:131]
    v_mfma_f32_16x16x32_bf16 v[132:135], v[60:63], v[92:95], v[132:135]
    v_mfma_f32_16x16x32_bf16 v[136:139], v[64:67], v[92:95], v[136:139]
    v_mfma_f32_16x16x32_bf16 v[140:143], v[68:71], v[92:95], v[140:143]
    ds_read_b128 v[88:91], v149 offset:2624
    ds_read_b128 v[92:95], v149 offset:6976
    s_waitcnt lgkmcnt(5)
    v_mfma_f32_16x16x32_bf16 v[124:127], v[48:51], v[96:99], v[124:127]
    v_mfma_f32_16x16x32_bf16 v[128:131], v[52:55], v[96:99], v[128:131]
    v_mfma_f32_16x16x32_bf16 v[132:135], v[56:59], v[96:99], v[132:135]
    v_mfma_f32_16x16x32_bf16 v[136:139], v[60:63], v[96:99], v[136:139]
    v_mfma_f32_16x16x32_bf16 v[140:143], v[64:67], v[96:99], v[140:143]
    s_waitcnt lgkmcnt(4)
    v_mfma_f32_16x16x32_bf16 v[124:127], v[48:51], v[100:103], v[124:127]
    v_mfma_f32_16x16x32_bf16 v[128:131], v[52:55], v[100:103], v[128:131]
    v_mfma_f32_16x16x32_bf16 v[132:135], v[56:59], v[100:103], v[132:135]
    v_mfma_f32_16x16x32_bf16 v[136:139], v[60:63], v[100:103], v[136:139]
    v_mfma_f32_16x16x32_bf16 v[140:143], v[64:67], v[100:103], v[140:143]
    ds_read_b128 v[96:99], v149 offset:3136
    ds_read_b128 v[100:103], v149 offset:7488
    s_waitcnt lgkmcnt(5)
    v_mfma_f32_16x16x32_bf16 v[128:131], v[48:51], v[80:83], v[128:131]
    v_mfma_f32_16x16x32_bf16 v[132:135], v[52:55], v[80:83], v[132:135]
    v_mfma_f32_16x16x32_bf16 v[136:139], v[56:59], v[80:83], v[136:139]
    v_mfma_f32_16x16x32_bf16 v[140:143], v[60:63], v[80:83], v[140:143]
    s_waitcnt lgkmcnt(4)
    v_mfma_f32_16x16x32_bf16 v[128:131], v[48:51], v[84:87], v[128:131]
    v_mfma_f32_16x16x32_bf16 v[132:135], v[52:55], v[84:87], v[132:135]
    v_mfma_f32_16x16x32_bf16 v[136:139], v[56:59], v[84:87], v[136:139]
    v_mfma_f32_16x16x32_bf16 v[140:143], v[60:63], v[84:87], v[140:143]
    ds_read_b128 v[80:83], v149 offset:3648
    ds_read_b128 v[84:87], v149 offset:8000
    s_waitcnt lgkmcnt(5)
    v_mfma_f32_16x16x32_bf16 v[132:135], v[48:51], v[88:91], v[132:135]
    v_mfma_f32_16x16x32_bf16 v[136:139], v[52:55], v[88:91], v[136:139]
    v_mfma_f32_16x16x32_bf16 v[140:143], v[56:59], v[88:91], v[140:143]
    s_waitcnt lgkmcnt(4)
    v_mfma_f32_16x16x32_bf16 v[132:135], v[48:51], v[92:95], v[132:135]
    v_mfma_f32_16x16x32_bf16 v[136:139], v[52:55], v[92:95], v[136:139]
    v_mfma_f32_16x16x32_bf16 v[140:143], v[56:59], v[92:95], v[140:143]
    s_waitcnt lgkmcnt(3)
    v_mfma_f32_16x16x32_bf16 v[136:139], v[48:51], v[96:99], v[136:139]
    v_mfma_f32_16x16x32_bf16 v[140:143], v[52:55], v[96:99], v[140:143]
    s_waitcnt lgkmcnt(2)
    v_mfma_f32_16x16x32_bf16 v[136:139], v[48:51], v[100:103], v[136:139]
    v_mfma_f32_16x16x32_bf16 v[140:143], v[52:55], v[100:103], v[140:143]
    s_waitcnt lgkmcnt(1)
    v_mfma_f32_16x16x32_bf16 v[140:143], v[48:51], v[80:83], v[140:143]
    s_waitcnt lgkmcnt(0)
    v_mfma_f32_16x16x32_bf16 v[140:143], v[48:51], v[84:87], v[140:143]
    ds_write_b128 v150, v[112:115] offset:0
    ds_write_b128 v150, v[116:119] offset:1024
    ds_write_b128 v150, v[120:123] offset:2048
    ds_write_b128 v150, v[124:127] offset:3072
    ds_write_b128 v150, v[128:131] offset:4096
    ds_write_b128 v150, v[132:135] offset:5120
    ds_write_b128 v150, v[136:139] offset:6144
    s_nop 0
    ds_write_b128 v150, v[140:143] offset:7168
    v_lshlrev_b32 v1, 4, v0
    v_add_u32 v2, 93184, v1
    s_waitcnt lgkmcnt(0)
    s_barrier
    ds_read_b128 v[16:19], v2 offset:0
    ds_read_b128 v[20:23], v2 offset:8192
    ds_read_b128 v[24:27], v2 offset:16384
    ds_read_b128 v[28:31], v2 offset:24576
    ds_read_b128 v[32:35], v2 offset:32768
    ds_read_b128 v[36:39], v2 offset:40960
    ds_read_b128 v[40:43], v2 offset:49152
    ds_read_b128 v[44:47], v2 offset:57344
    s_waitcnt lgkmcnt(0)
    v_add_f32 v16, v16, v20
    v_add_f32 v24, v24, v28
    v_add_f32 v16, v16, v24
    v_add_f32 v17, v17, v21
    v_add_f32 v25, v25, v29
    v_add_f32 v17, v17, v25
    v_add_f32 v18, v18, v22
    v_add_f32 v26, v26, v30
    v_add_f32 v18, v18, v26
    v_add_f32 v19, v19, v23
    v_add_f32 v27, v27, v31
    v_add_f32 v19, v19, v27
    v_add_f32 v32, v32, v36
    v_add_f32 v40, v40, v44
    v_add_f32 v32, v32, v40
    v_add_f32 v33, v33, v37
    v_add_f32 v41, v41, v45
    v_add_f32 v33, v33, v41
    v_add_f32 v34, v34, v38
    v_add_f32 v42, v42, v46
    v_add_f32 v34, v34, v42
    v_add_f32 v35, v35, v39
    v_add_f32 v43, v43, v47
    v_add_f32 v35, v35, v43
    v_cvt_pk_bf16_f32 v50, v16, v32
    v_and_b32 v51, 0xffff0000, v50
    v_lshlrev_b32 v50, 16, v50
    v_add_f32 v50, v50, v152
    v_add_f32 v51, v51, v153
    v_cvt_pk_bf16_f32 v52, v50, v51
    v_cvt_pk_bf16_f32 v50, v17, v33
    v_and_b32 v51, 0xffff0000, v50
    v_lshlrev_b32 v50, 16, v50
    v_add_f32 v50, v50, v154
    v_add_f32 v51, v51, v155
    v_cvt_pk_bf16_f32 v53, v50, v51
    v_cvt_pk_bf16_f32 v50, v18, v34
    v_and_b32 v51, 0xffff0000, v50
    v_lshlrev_b32 v50, 16, v50
    v_add_f32 v50, v50, v156
    v_add_f32 v51, v51, v157
    v_cvt_pk_bf16_f32 v54, v50, v51
    v_cvt_pk_bf16_f32 v50, v19, v35
    v_and_b32 v51, 0xffff0000, v50
    v_lshlrev_b32 v50, 16, v50
    v_add_f32 v50, v50, v158
    v_add_f32 v51, v51, v159
    v_cvt_pk_bf16_f32 v55, v50, v51
    buffer_store_dwordx4 v[52:55], v1, s[16:19], 0 offen sc1
    s_mov_b32 s2, s90
    s_branch KA_end
KA_lnb:
    s_waitcnt vmcnt(6)
    v_lshlrev_b32 v40, 16, v8
    v_and_b32 v41, 0xffff0000, v8
    v_lshlrev_b32 v42, 16, v9
    v_and_b32 v43, 0xffff0000, v9
    v_lshlrev_b32 v44, 16, v10
    v_and_b32 v45, 0xffff0000, v10
    v_lshlrev_b32 v46, 16, v11
    v_and_b32 v47, 0xffff0000, v11
    s_waitcnt vmcnt(5)
    v_lshlrev_b32 v48, 16, v12
    v_and_b32 v49, 0xffff0000, v12
    v_lshlrev_b32 v50, 16, v13
    v_and_b32 v51, 0xffff0000, v13
    v_lshlrev_b32 v52, 16, v14
    v_and_b32 v53, 0xffff0000, v14
    v_lshlrev_b32 v54, 16, v15
    v_and_b32 v55, 0xffff0000, v15
    s_waitcnt vmcnt(4)
    v_lshlrev_b32 v56, 16, v16
    v_and_b32 v57, 0xffff0000, v16
    v_lshlrev_b32 v58, 16, v17
    v_and_b32 v59, 0xffff0000, v17
    v_lshlrev_b32 v60, 16, v18
    v_and_b32 v61, 0xffff0000, v18
    v_lshlrev_b32 v62, 16, v19
    v_and_b32 v63, 0xffff0000, v19
    s_waitcnt vmcnt(3)
    v_lshlrev_b32 v64, 16, v20
    v_and_b32 v65, 0xffff0000, v20
    v_lshlrev_b32 v66, 16, v21
    v_and_b32 v67, 0xffff0000, v21
    v_lshlrev_b32 v68, 16, v22
    v_and_b32 v69, 0xffff0000, v22
    v_lshlrev_b32 v70, 16, v23
    v_and_b32 v71, 0xffff0000, v23
    s_waitcnt vmcnt(2)
    v_lshlrev_b32 v72, 16, v24
    v_and_b32 v73, 0xffff0000, v24
    v_lshlrev_b32 v74, 16, v25
    v_and_b32 v75, 0xffff0000, v25
    v_lshlrev_b32 v76, 16, v26
    v_and_b32 v77, 0xffff0000, v26
    v_lshlrev_b32 v78, 16, v27
    v_and_b32 v79, 0xffff0000, v27
    s_waitcnt vmcnt(1)
    v_lshlrev_b32 v80, 16, v28
    v_and_b32 v81, 0xffff0000, v28
    v_lshlrev_b32 v82, 16, v29
    v_and_b32 v83, 0xffff0000, v29
    v_lshlrev_b32 v84, 16, v30
    v_and_b32 v85, 0xffff0000, v30
    v_lshlrev_b32 v86, 16, v31
    v_and_b32 v87, 0xffff0000, v31
    s_waitcnt vmcnt(0)
    v_lshlrev_b32 v88, 16, v32
    v_and_b32 v89, 0xffff0000, v32
    v_lshlrev_b32 v90, 16, v33
    v_and_b32 v91, 0xffff0000, v33
    v_lshlrev_b32 v92, 16, v34
    v_and_b32 v93, 0xffff0000, v34
    v_lshlrev_b32 v94, 16, v35
    v_and_b32 v95, 0xffff0000, v35
    v_add_f32 v100, v40, v44
    v_add_f32 v101, v41, v45
    v_add_f32 v102, v42, v46
    v_add_f32 v103, v43, v47
    v_add_f32 v100, v100, v48
    v_add_f32 v101, v101, v49
    v_add_f32 v102, v102, v50
    v_add_f32 v103, v103, v51
    v_add_f32 v100, v100, v52
    v_add_f32 v101, v101, v53
    v_add_f32 v102, v102, v54
    v_add_f32 v103, v103, v55
    v_add_f32 v100, v100, v56
    v_add_f32 v101, v101, v57
    v_add_f32 v102, v102, v58
    v_add_f32 v103, v103, v59
    v_add_f32 v100, v100, v60
    v_add_f32 v101, v101, v61
    v_add_f32 v102, v102, v62
    v_add_f32 v103, v103, v63
    v_add_f32 v100, v100, v64
    v_add_f32 v101, v101, v65
    v_add_f32 v102, v102, v66
    v_add_f32 v103, v103, v67
    v_add_f32 v100, v100, v68
    v_add_f32 v101, v101, v69
    v_add_f32 v102, v102, v70
    v_add_f32 v103, v103, v71
    v_add_f32 v100, v100, v72
    v_add_f32 v101, v101, v73
    v_add_f32 v102, v102, v74
    v_add_f32 v103, v103, v75
    v_add_f32 v100, v100, v76
    v_add_f32 v101, v101, v77
    v_add_f32 v102, v102, v78
    v_add_f32 v103, v103, v79
    v_add_f32 v100, v100, v80
    v_add_f32 v101, v101, v81
    v_add_f32 v102, v102, v82
    v_add_f32 v103, v103, v83
    v_add_f32 v100, v100, v84
    v_add_f32 v101, v101, v85
    v_add_f32 v102, v102, v86
    v_add_f32 v103, v103, v87
    v_add_f32 v100, v100, v88
    v_add_f32 v101, v101, v89
    v_add_f32 v102, v102, v90
    v_add_f32 v103, v103, v91
    v_add_f32 v100, v100, v92
    v_add_f32 v101, v101, v93
    v_add_f32 v102, v102, v94
    v_add_f32 v103, v103, v95
    v_add_f32 v100, v100, v101
    v_add_f32 v102, v102, v103
    v_add_f32 v100, v100, v102
    s_nop 1
    v_add_f32 v100, v100, v100 quad_perm:[1,0,3,2] row_mask:0xf bank_mask:0xf
    s_nop 1
    v_add_f32 v100, v100, v100 quad_perm:[2,3,0,1] row_mask:0xf bank_mask:0xf
    s_nop 1
    v_add_f32 v100, v100, v100 row_half_mirror row_mask:0xf bank_mask:0xf
    v_mul_f32 v112, s20, v100
    v_sub_f32 v110, v40, v112
    v_mul_f32 v100, v110, v110
    v_sub_f32 v110, v41, v112
    v_mul_f32 v101, v110, v110
    v_sub_f32 v110, v42, v112
    v_mul_f32 v102, v110, v110
    v_sub_f32 v110, v43, v112
    v_mul_f32 v103, v110, v110
    v_sub_f32 v110, v44, v112
    v_fmac_f32 v100, v110, v110
    v_sub_f32 v110, v45, v112
    v_fmac_f32 v101, v110, v110
    v_sub_f32 v110, v46, v112
    v_fmac_f32 v102, v110, v110
    v_sub_f32 v110, v47, v112
    v_fmac_f32 v103, v110, v110
    v_sub_f32 v110, v48, v112
    v_fmac_f32 v100, v110, v110
    v_sub_f32 v110, v49, v112
    v_fmac_f32 v101, v110, v110
    v_sub_f32 v110, v50, v112
    v_fmac_f32 v102, v110, v110
    v_sub_f32 v110, v51, v112
    v_fmac_f32 v103, v110, v110
    v_sub_f32 v110, v52, v112
    v_fmac_f32 v100, v110, v110
    v_sub_f32 v110, v53, v112
    v_fmac_f32 v101, v110, v110
    v_sub_f32 v110, v54, v112
    v_fmac_f32 v102, v110, v110
    v_sub_f32 v110, v55, v112
    v_fmac_f32 v103, v110, v110
    v_sub_f32 v110, v56, v112
    v_fmac_f32 v100, v110, v110
    v_sub_f32 v110, v57, v112
    v_fmac_f32 v101, v110, v110
    v_sub_f32 v110, v58, v112
    v_fmac_f32 v102, v110, v110
    v_sub_f32 v110, v59, v112
    v_fmac_f32 v103, v110, v110
    v_sub_f32 v110, v60, v112
    v_fmac_f32 v100, v110, v110
    v_sub_f32 v110, v61, v112
    v_fmac_f32 v101, v110, v110
    v_sub_f32 v110, v62, v112
    v_fmac_f32 v102, v110, v110
    v_sub_f32 v110, v63, v112
    v_fmac_f32 v103, v110, v110
    v_sub_f32 v110, v64, v112
    v_fmac_f32 v100, v110, v110
    v_sub_f32 v110, v65, v112
    v_fmac_f32 v101, v110, v110
    v_sub_f32 v110, v66, v112
    v_fmac_f32 v102, v110, v110
    v_sub_f32 v110, v67, v112
    v_fmac_f32 v103, v110, v110
    v_sub_f32 v110, v68, v112
    v_fmac_f32 v100, v110, v110
    v_sub_f32 v110, v69, v112
    v_fmac_f32 v101, v110, v110
    v_sub_f32 v110, v70, v112
    v_fmac_f32 v102, v110, v110
    v_sub_f32 v110, v71, v112
    v_fmac_f32 v103, v110, v110
    v_sub_f32 v110, v72, v112
    v_fmac_f32 v100, v110, v110
    v_sub_f32 v110, v73, v112
    v_fmac_f32 v101, v110, v110
    v_sub_f32 v110, v74, v112
    v_fmac_f32 v102, v110, v110
    v_sub_f32 v110, v75, v112
    v_fmac_f32 v103, v110, v110
    v_sub_f32 v110, v76, v112
    v_fmac_f32 v100, v110, v110
    v_sub_f32 v110, v77, v112
    v_fmac_f32 v101, v110, v110
    v_sub_f32 v110, v78, v112
    v_fmac_f32 v102, v110, v110
    v_sub_f32 v110, v79, v112
    v_fmac_f32 v103, v110, v110
    v_sub_f32 v110, v80, v112
    v_fmac_f32 v100, v110, v110
    v_sub_f32 v110, v81, v112
    v_fmac_f32 v101, v110, v110
    v_sub_f32 v110, v82, v112
    v_fmac_f32 v102, v110, v110
    v_sub_f32 v110, v83, v112
    v_fmac_f32 v103, v110, v110
    v_sub_f32 v110, v84, v112
    v_fmac_f32 v100, v110, v110
    v_sub_f32 v110, v85, v112
    v_fmac_f32 v101, v110, v110
    v_sub_f32 v110, v86, v112
    v_fmac_f32 v102, v110, v110
    v_sub_f32 v110, v87, v112
    v_fmac_f32 v103, v110, v110
    v_sub_f32 v110, v88, v112
    v_fmac_f32 v100, v110, v110
    v_sub_f32 v110, v89, v112
    v_fmac_f32 v101, v110, v110
    v_sub_f32 v110, v90, v112
    v_fmac_f32 v102, v110, v110
    v_sub_f32 v110, v91, v112
    v_fmac_f32 v103, v110, v110
    v_sub_f32 v110, v92, v112
    v_fmac_f32 v100, v110, v110
    v_sub_f32 v110, v93, v112
    v_fmac_f32 v101, v110, v110
    v_sub_f32 v110, v94, v112
    v_fmac_f32 v102, v110, v110
    v_sub_f32 v110, v95, v112
    v_fmac_f32 v103, v110, v110
    v_add_f32 v100, v100, v101
    v_add_f32 v102, v102, v103
    v_add_f32 v100, v100, v102
    s_nop 1
    v_add_f32 v100, v100, v100 quad_perm:[1,0,3,2] row_mask:0xf bank_mask:0xf
    s_nop 1
    v_add_f32 v100, v100, v100 quad_perm:[2,3,0,1] row_mask:0xf bank_mask:0xf
    s_nop 1
    v_add_f32 v100, v100, v100 row_half_mirror row_mask:0xf bank_mask:0xf
    v_cvt_pk_bf16_f32 v110, v112, v112
    v_and_b32 v110, 0xffff0000, v110
    v_mul_f32 v100, s20, v100
    v_cvt_pk_bf16_f32 v100, v100, v100
    v_and_b32 v100, 0xffff0000, v100
    v_add_f32 v100, s21, v100
    v_cvt_pk_bf16_f32 v100, v100, v100
    v_and_b32 v100, 0xffff0000, v100
    v_sqrt_f32 v100, v100
    s_nop 0
    v_cvt_pk_bf16_f32 v100, v100, v100
    v_and_b32 v100, 0xffff0000, v100
    v_rcp_f32 v112, v100
    v_sub_f32 v40, v40, v110
    v_sub_f32 v41, v41, v110
    v_cvt_pk_bf16_f32 v40, v40, v41
    v_and_b32 v41, 0xffff0000, v40
    v_lshlrev_b32 v40, 16, v40
    v_mul_f32 v40, v40, v112
    v_mul_f32 v41, v41, v112
    v_cvt_pk_bf16_f32 v8, v40, v41
    v_sub_f32 v42, v42, v110
    v_sub_f32 v43, v43, v110
    v_cvt_pk_bf16_f32 v42, v42, v43
    v_and_b32 v43, 0xffff0000, v42
    v_lshlrev_b32 v42, 16, v42
    v_mul_f32 v42, v42, v112
    v_mul_f32 v43, v43, v112
    v_cvt_pk_bf16_f32 v9, v42, v43
    v_sub_f32 v44, v44, v110
    v_sub_f32 v45, v45, v110
    v_cvt_pk_bf16_f32 v44, v44, v45
    v_and_b32 v45, 0xffff0000, v44
    v_lshlrev_b32 v44, 16, v44
    v_mul_f32 v44, v44, v112
    v_mul_f32 v45, v45, v112
    v_cvt_pk_bf16_f32 v10, v44, v45
    v_sub_f32 v46, v46, v110
    v_sub_f32 v47, v47, v110
    v_cvt_pk_bf16_f32 v46, v46, v47
    v_and_b32 v47, 0xffff0000, v46
    v_lshlrev_b32 v46, 16, v46
    v_mul_f32 v46, v46, v112
    v_mul_f32 v47, v47, v112
    v_cvt_pk_bf16_f32 v11, v46, v47
    s_mov_b32 s22, 0
    buffer_store_dwordx4 v[8:11], v4, s[16:19], s22 offen sc1
    v_sub_f32 v48, v48, v110
    v_sub_f32 v49, v49, v110
    v_cvt_pk_bf16_f32 v48, v48, v49
    v_and_b32 v49, 0xffff0000, v48
    v_lshlrev_b32 v48, 16, v48
    v_mul_f32 v48, v48, v112
    v_mul_f32 v49, v49, v112
    v_cvt_pk_bf16_f32 v12, v48, v49
    v_sub_f32 v50, v50, v110
    v_sub_f32 v51, v51, v110
    v_cvt_pk_bf16_f32 v50, v50, v51
    v_and_b32 v51, 0xffff0000, v50
    v_lshlrev_b32 v50, 16, v50
    v_mul_f32 v50, v50, v112
    v_mul_f32 v51, v51, v112
    v_cvt_pk_bf16_f32 v13, v50, v51
    v_sub_f32 v52, v52, v110
    v_sub_f32 v53, v53, v110
    v_cvt_pk_bf16_f32 v52, v52, v53
    v_and_b32 v53, 0xffff0000, v52
    v_lshlrev_b32 v52, 16, v52
    v_mul_f32 v52, v52, v112
    v_mul_f32 v53, v53, v112
    v_cvt_pk_bf16_f32 v14, v52, v53
    v_sub_f32 v54, v54, v110
    v_sub_f32 v55, v55, v110
    v_cvt_pk_bf16_f32 v54, v54, v55
    v_and_b32 v55, 0xffff0000, v54
    v_lshlrev_b32 v54, 16, v54
    v_mul_f32 v54, v54, v112
    v_mul_f32 v55, v55, v112
    v_cvt_pk_bf16_f32 v15, v54, v55
    s_mov_b32 s22, 262144
    buffer_store_dwordx4 v[12:15], v4, s[16:19], s22 offen sc1
    v_sub_f32 v56, v56, v110
    v_sub_f32 v57, v57, v110
    v_cvt_pk_bf16_f32 v56, v56, v57
    v_and_b32 v57, 0xffff0000, v56
    v_lshlrev_b32 v56, 16, v56
    v_mul_f32 v56, v56, v112
    v_mul_f32 v57, v57, v112
    v_cvt_pk_bf16_f32 v16, v56, v57
    v_sub_f32 v58, v58, v110
    v_sub_f32 v59, v59, v110
    v_cvt_pk_bf16_f32 v58, v58, v59
    v_and_b32 v59, 0xffff0000, v58
    v_lshlrev_b32 v58, 16, v58
    v_mul_f32 v58, v58, v112
    v_mul_f32 v59, v59, v112
    v_cvt_pk_bf16_f32 v17, v58, v59
    v_sub_f32 v60, v60, v110
    v_sub_f32 v61, v61, v110
    v_cvt_pk_bf16_f32 v60, v60, v61
    v_and_b32 v61, 0xffff0000, v60
    v_lshlrev_b32 v60, 16, v60
    v_mul_f32 v60, v60, v112
    v_mul_f32 v61, v61, v112
    v_cvt_pk_bf16_f32 v18, v60, v61
    v_sub_f32 v62, v62, v110
    v_sub_f32 v63, v63, v110
    v_cvt_pk_bf16_f32 v62, v62, v63
    v_and_b32 v63, 0xffff0000, v62
    v_lshlrev_b32 v62, 16, v62
    v_mul_f32 v62, v62, v112
    v_mul_f32 v63, v63, v112
    v_cvt_pk_bf16_f32 v19, v62, v63
    s_mov_b32 s22, 524288
    buffer_store_dwordx4 v[16:19], v4, s[16:19], s22 offen sc1
    v_sub_f32 v64, v64, v110
    v_sub_f32 v65, v65, v110
    v_cvt_pk_bf16_f32 v64, v64, v65
    v_and_b32 v65, 0xffff0000, v64
    v_lshlrev_b32 v64, 16, v64
    v_mul_f32 v64, v64, v112
    v_mul_f32 v65, v65, v112
    v_cvt_pk_bf16_f32 v20, v64, v65
    v_sub_f32 v66, v66, v110
    v_sub_f32 v67, v67, v110
    v_cvt_pk_bf16_f32 v66, v66, v67
    v_and_b32 v67, 0xffff0000, v66
    v_lshlrev_b32 v66, 16, v66
    v_mul_f32 v66, v66, v112
    v_mul_f32 v67, v67, v112
    v_cvt_pk_bf16_f32 v21, v66, v67
    v_sub_f32 v68, v68, v110
    v_sub_f32 v69, v69, v110
    v_cvt_pk_bf16_f32 v68, v68, v69
    v_and_b32 v69, 0xffff0000, v68
    v_lshlrev_b32 v68, 16, v68
    v_mul_f32 v68, v68, v112
    v_mul_f32 v69, v69, v112
    v_cvt_pk_bf16_f32 v22, v68, v69
    v_sub_f32 v70, v70, v110
    v_sub_f32 v71, v71, v110
    v_cvt_pk_bf16_f32 v70, v70, v71
    v_and_b32 v71, 0xffff0000, v70
    v_lshlrev_b32 v70, 16, v70
    v_mul_f32 v70, v70, v112
    v_mul_f32 v71, v71, v112
    v_cvt_pk_bf16_f32 v23, v70, v71
    s_mov_b32 s22, 786432
    buffer_store_dwordx4 v[20:23], v4, s[16:19], s22 offen sc1
    v_sub_f32 v72, v72, v110
    v_sub_f32 v73, v73, v110
    v_cvt_pk_bf16_f32 v72, v72, v73
    v_and_b32 v73, 0xffff0000, v72
    v_lshlrev_b32 v72, 16, v72
    v_mul_f32 v72, v72, v112
    v_mul_f32 v73, v73, v112
    v_cvt_pk_bf16_f32 v24, v72, v73
    v_sub_f32 v74, v74, v110
    v_sub_f32 v75, v75, v110
    v_cvt_pk_bf16_f32 v74, v74, v75
    v_and_b32 v75, 0xffff0000, v74
    v_lshlrev_b32 v74, 16, v74
    v_mul_f32 v74, v74, v112
    v_mul_f32 v75, v75, v112
    v_cvt_pk_bf16_f32 v25, v74, v75
    v_sub_f32 v76, v76, v110
    v_sub_f32 v77, v77, v110
    v_cvt_pk_bf16_f32 v76, v76, v77
    v_and_b32 v77, 0xffff0000, v76
    v_lshlrev_b32 v76, 16, v76
    v_mul_f32 v76, v76, v112
    v_mul_f32 v77, v77, v112
    v_cvt_pk_bf16_f32 v26, v76, v77
    v_sub_f32 v78, v78, v110
    v_sub_f32 v79, v79, v110
    v_cvt_pk_bf16_f32 v78, v78, v79
    v_and_b32 v79, 0xffff0000, v78
    v_lshlrev_b32 v78, 16, v78
    v_mul_f32 v78, v78, v112
    v_mul_f32 v79, v79, v112
    v_cvt_pk_bf16_f32 v27, v78, v79
    s_mov_b32 s22, 1048576
    buffer_store_dwordx4 v[24:27], v4, s[16:19], s22 offen sc1
    v_sub_f32 v80, v80, v110
    v_sub_f32 v81, v81, v110
    v_cvt_pk_bf16_f32 v80, v80, v81
    v_and_b32 v81, 0xffff0000, v80
    v_lshlrev_b32 v80, 16, v80
    v_mul_f32 v80, v80, v112
    v_mul_f32 v81, v81, v112
    v_cvt_pk_bf16_f32 v28, v80, v81
    v_sub_f32 v82, v82, v110
    v_sub_f32 v83, v83, v110
    v_cvt_pk_bf16_f32 v82, v82, v83
    v_and_b32 v83, 0xffff0000, v82
    v_lshlrev_b32 v82, 16, v82
    v_mul_f32 v82, v82, v112
    v_mul_f32 v83, v83, v112
    v_cvt_pk_bf16_f32 v29, v82, v83
    v_sub_f32 v84, v84, v110
    v_sub_f32 v85, v85, v110
    v_cvt_pk_bf16_f32 v84, v84, v85
    v_and_b32 v85, 0xffff0000, v84
    v_lshlrev_b32 v84, 16, v84
    v_mul_f32 v84, v84, v112
    v_mul_f32 v85, v85, v112
    v_cvt_pk_bf16_f32 v30, v84, v85
    v_sub_f32 v86, v86, v110
    v_sub_f32 v87, v87, v110
    v_cvt_pk_bf16_f32 v86, v86, v87
    v_and_b32 v87, 0xffff0000, v86
    v_lshlrev_b32 v86, 16, v86
    v_mul_f32 v86, v86, v112
    v_mul_f32 v87, v87, v112
    v_cvt_pk_bf16_f32 v31, v86, v87
    s_mov_b32 s22, 1310720
    buffer_store_dwordx4 v[28:31], v4, s[16:19], s22 offen sc1
    v_sub_f32 v88, v88, v110
    v_sub_f32 v89, v89, v110
    v_cvt_pk_bf16_f32 v88, v88, v89
    v_and_b32 v89, 0xffff0000, v88
    v_lshlrev_b32 v88, 16, v88
    v_mul_f32 v88, v88, v112
    v_mul_f32 v89, v89, v112
    v_cvt_pk_bf16_f32 v32, v88, v89
    v_sub_f32 v90, v90, v110
    v_sub_f32 v91, v91, v110
    v_cvt_pk_bf16_f32 v90, v90, v91
    v_and_b32 v91, 0xffff0000, v90
    v_lshlrev_b32 v90, 16, v90
    v_mul_f32 v90, v90, v112
    v_mul_f32 v91, v91, v112
    v_cvt_pk_bf16_f32 v33, v90, v91
    v_sub_f32 v92, v92, v110
    v_sub_f32 v93, v93, v110
    v_cvt_pk_bf16_f32 v92, v92, v93
    v_and_b32 v93, 0xffff0000, v92
    v_lshlrev_b32 v92, 16, v92
    v_mul_f32 v92, v92, v112
    v_mul_f32 v93, v93, v112
    v_cvt_pk_bf16_f32 v34, v92, v93
    v_sub_f32 v94, v94, v110
    v_sub_f32 v95, v95, v110
    v_cvt_pk_bf16_f32 v94, v94, v95
    v_and_b32 v95, 0xffff0000, v94
    v_lshlrev_b32 v94, 16, v94
    v_mul_f32 v94, v94, v112
    v_mul_f32 v95, v95, v112
    v_cvt_pk_bf16_f32 v35, v94, v95
    s_mov_b32 s22, 1572864
    buffer_store_dwordx4 v[32:35], v4, s[16:19], s22 offen sc1
    s_waitcnt vmcnt(0)
    s_cmp_lt_u32 s2, 224
    s_cbranch_scc1 KA_sig
    s_barrier
KA_sig:
    s_and_b32 s29, s2, 3
    s_lshl_b32 s29, s29, 6
    v_mov_b32 v8, 1
    v_cmp_eq_u32 vcc, 0, v1
    v_bfrev_b32 v10, 1
    s_nop 0
    v_cndmask_b32 v9, v10, 0, vcc
    buffer_atomic_add v8, v9, s[24:27], s29 offen sc0
    s_waitcnt vmcnt(0)
    v_readfirstlane_b32 s30, v8
    s_nop 0
    s_cmp_lg_u32 s30, 105
    s_cbranch_scc1 KA_notlast
    v_not_b32 v12, v120
    buffer_store_dword v12, v121, s[44:47], 0 offen sc1
KA_notlast:
    v_mov_b32 v11, 93008
    ds_write_b128 v11, v[124:127]
    s_waitcnt lgkmcnt(0)
    s_branch KA_end
KA_rep:
    s_cmp_ge_u32 s2, 252
    s_cbranch_scc1 KA_end
    s_waitcnt lgkmcnt(0)
    s_load_dwordx4 s[8:11], s[0:1], 88
    s_load_dwordx2 s[24:25], s[0:1], 104
    s_sub_u32 s12, s2, 224
    s_lshl_b32 s12, s12, 3
    s_add_u32 s12, s12, s3
    s_mul_i32 s28, s12, 7168
    s_cmp_ge_u32 s12, 112
    s_cselect_b32 s13, 1, 0
    s_mul_i32 s14, s13, 112
    s_sub_u32 s12, s12, s14
    v_lshrrev_b32 v2, 4, v1
    v_and_b32 v3, 15, v1
    s_lshl_b32 s14, s12, 2
    v_add_u32 v2, s14, v2
    s_movk_i32 s15, 3584
    v_mul_lo_u32 v5, v2, s15
    v_lshl_add_u32 v5, v3, 4, v5
    v_lshrrev_b32 v6, 1, v3
    s_movk_i32 s15, 28672
    v_mul_lo_u32 v6, v6, s15
    v_lshl_add_u32 v6, v2, 5, v6
    v_and_b32 v7, 1, v3
    v_lshl_add_u32 v6, v7, 4, v6
    s_mul_i32 s15, s13, 14336
    v_add_u32 v6, s15, v6
    s_waitcnt lgkmcnt(0)
    s_cmp_eq_u32 s13, 1
    s_cselect_b32 s16, s10, s8
    s_cselect_b32 s17, s11, s9
    s_mov_b32 s18, 1605632
    s_mov_b32 s19, 0x00020000
    s_add_u32 s20, s4, 12582912
    s_addc_u32 s21, s5, 0
    s_mov_b32 s22, 3211264
    s_mov_b32 s23, 0x00020000
    s_barrier
    buffer_load_dwordx4 v[8:11], v5, s[16:19], 0 offen offset:0
    buffer_load_dwordx4 v[12:15], v5, s[16:19], 0 offen offset:256
    buffer_load_dwordx4 v[16:19], v5, s[16:19], 0 offen offset:512
    buffer_load_dwordx4 v[20:23], v5, s[16:19], 0 offen offset:768
    buffer_load_dwordx4 v[24:27], v5, s[16:19], 0 offen offset:1024
    buffer_load_dwordx4 v[28:31], v5, s[16:19], 0 offen offset:1280
    buffer_load_dwordx4 v[32:35], v5, s[16:19], 0 offen offset:1536
    buffer_load_dwordx4 v[36:39], v5, s[16:19], 0 offen offset:1792
    buffer_load_dwordx4 v[40:43], v5, s[16:19], 0 offen offset:2048
    buffer_load_dwordx4 v[44:47], v5, s[16:19], 0 offen offset:2304
    buffer_load_dwordx4 v[48:51], v5, s[16:19], 0 offen offset:2560
    buffer_load_dwordx4 v[52:55], v5, s[16:19], 0 offen offset:2816
    buffer_load_dwordx4 v[56:59], v5, s[16:19], 0 offen offset:3072
    buffer_load_dwordx4 v[60:63], v5, s[16:19], 0 offen offset:3328
    s_mov_b32 s15, 0
    s_waitcnt vmcnt(13)
    buffer_store_dwordx4 v[8:11], v6, s[20:23], s15 offen sc1
    s_mov_b32 s15, 229376
    s_waitcnt vmcnt(13)
    buffer_store_dwordx4 v[12:15], v6, s[20:23], s15 offen sc1
    s_mov_b32 s15, 458752
    s_waitcnt vmcnt(13)
    buffer_store_dwordx4 v[16:19], v6, s[20:23], s15 offen sc1
    s_mov_b32 s15, 688128
    s_waitcnt vmcnt(13)
    buffer_store_dwordx4 v[20:23], v6, s[20:23], s15 offen sc1
    s_mov_b32 s15, 917504
    s_waitcnt vmcnt(13)
    buffer_store_dwordx4 v[24:27], v6, s[20:23], s15 offen sc1
    s_mov_b32 s15, 1146880
    s_waitcnt vmcnt(13)
    buffer_store_dwordx4 v[28:31], v6, s[20:23], s15 offen sc1
    s_mov_b32 s15, 1376256
    s_waitcnt vmcnt(13)
    buffer_store_dwordx4 v[32:35], v6, s[20:23], s15 offen sc1
    s_mov_b32 s15, 1605632
    s_waitcnt vmcnt(13)
    buffer_store_dwordx4 v[36:39], v6, s[20:23], s15 offen sc1
    s_mov_b32 s15, 1835008
    s_waitcnt vmcnt(13)
    buffer_store_dwordx4 v[40:43], v6, s[20:23], s15 offen sc1
    s_mov_b32 s15, 2064384
    s_waitcnt vmcnt(13)
    buffer_store_dwordx4 v[44:47], v6, s[20:23], s15 offen sc1
    s_mov_b32 s15, 2293760
    s_waitcnt vmcnt(13)
    buffer_store_dwordx4 v[48:51], v6, s[20:23], s15 offen sc1
    s_mov_b32 s15, 2523136
    s_waitcnt vmcnt(13)
    buffer_store_dwordx4 v[52:55], v6, s[20:23], s15 offen sc1
    s_mov_b32 s15, 2752512
    s_waitcnt vmcnt(13)
    buffer_store_dwordx4 v[56:59], v6, s[20:23], s15 offen sc1
    s_mov_b32 s15, 2981888
    s_waitcnt vmcnt(13)
    buffer_store_dwordx4 v[60:63], v6, s[20:23], s15 offen sc1
    s_mov_b32 s26, 1605632
    s_mov_b32 s27, 0x00020000
    v_lshlrev_b32 v7, 4, v1
    s_add_u32 s15, s28, 0
    buffer_load_dwordx4 v[64:67], v7, s[24:27], s15 offen
    s_add_u32 s15, s28, 1024
    buffer_load_dwordx4 v[68:71], v7, s[24:27], s15 offen
    s_add_u32 s15, s28, 2048
    buffer_load_dwordx4 v[72:75], v7, s[24:27], s15 offen
    s_add_u32 s15, s28, 3072
    buffer_load_dwordx4 v[76:79], v7, s[24:27], s15 offen
    s_add_u32 s15, s28, 4096
    buffer_load_dwordx4 v[80:83], v7, s[24:27], s15 offen
    s_add_u32 s15, s28, 5120
    buffer_load_dwordx4 v[84:87], v7, s[24:27], s15 offen
    s_add_u32 s15, s28, 6144
    buffer_load_dwordx4 v[88:91], v7, s[24:27], s15 offen
    s_waitcnt vmcnt(0)
    s_branch KA_end
KA_modb:
    s_mov_b32 s14, 3216550459
    s_waitcnt vmcnt(14)
    v_lshlrev_b32 v8, 16, v8
    v_mul_f32 v80, s14, v8
    v_lshlrev_b32 v9, 16, v9
    v_mul_f32 v81, s14, v9
    v_lshlrev_b32 v10, 16, v10
    v_mul_f32 v82, s14, v10
    v_lshlrev_b32 v11, 16, v11
    v_mul_f32 v83, s14, v11
    v_lshlrev_b32 v12, 16, v12
    v_mul_f32 v84, s14, v12
    v_lshlrev_b32 v13, 16, v13
    v_mul_f32 v85, s14, v13
    v_lshlrev_b32 v14, 16, v14
    v_mul_f32 v86, s14, v14
    v_lshlrev_b32 v15, 16, v15
    v_mul_f32 v87, s14, v15
    v_lshlrev_b32 v16, 16, v16
    v_mul_f32 v88, s14, v16
    v_lshlrev_b32 v17, 16, v17
    v_mul_f32 v89, s14, v17
    v_lshlrev_b32 v18, 16, v18
    v_mul_f32 v90, s14, v18
    v_lshlrev_b32 v19, 16, v19
    v_mul_f32 v91, s14, v19
    v_lshlrev_b32 v20, 16, v20
    v_mul_f32 v92, s14, v20
    v_lshlrev_b32 v21, 16, v21
    v_mul_f32 v93, s14, v21
    v_exp_f32 v80, v80
    v_exp_f32 v81, v81
    v_exp_f32 v82, v82
    v_exp_f32 v83, v83
    v_exp_f32 v84, v84
    v_exp_f32 v85, v85
    v_exp_f32 v86, v86
    v_exp_f32 v87, v87
    v_exp_f32 v88, v88
    v_exp_f32 v89, v89
    v_exp_f32 v90, v90
    v_exp_f32 v91, v91
    v_exp_f32 v92, v92
    v_exp_f32 v93, v93
    v_add_f32 v80, 1.0, v80
    v_add_f32 v81, 1.0, v81
    v_add_f32 v82, 1.0, v82
    v_add_f32 v83, 1.0, v83
    v_add_f32 v84, 1.0, v84
    v_add_f32 v85, 1.0, v85
    v_add_f32 v86, 1.0, v86
    v_add_f32 v87, 1.0, v87
    v_add_f32 v88, 1.0, v88
    v_add_f32 v89, 1.0, v89
    v_add_f32 v90, 1.0, v90
    v_add_f32 v91, 1.0, v91
    v_add_f32 v92, 1.0, v92
    v_add_f32 v93, 1.0, v93
    v_rcp_f32 v80, v80
    v_rcp_f32 v81, v81
    v_rcp_f32 v82, v82
    v_rcp_f32 v83, v83
    v_rcp_f32 v84, v84
    v_rcp_f32 v85, v85
    v_rcp_f32 v86, v86
    v_rcp_f32 v87, v87
    v_rcp_f32 v88, v88
    v_rcp_f32 v89, v89
    v_rcp_f32 v90, v90
    v_rcp_f32 v91, v91
    v_rcp_f32 v92, v92
    v_rcp_f32 v93, v93
    v_mul_f32 v8, v8, v80
    v_mul_f32 v9, v9, v81
    v_mul_f32 v10, v10, v82
    v_mul_f32 v11, v11, v83
    v_mul_f32 v12, v12, v84
    v_mul_f32 v13, v13, v85
    v_mul_f32 v14, v14, v86
    v_mul_f32 v15, v15, v87
    v_mul_f32 v16, v16, v88
    v_mul_f32 v17, v17, v89
    v_mul_f32 v18, v18, v90
    v_mul_f32 v19, v19, v91
    v_mul_f32 v20, v20, v92
    v_mul_f32 v21, v21, v93
    v_cvt_pk_bf16_f32 v8, v8, v9
    v_and_b32 v9, 0xffff0000, v8
    v_lshlrev_b32 v8, 16, v8
    v_cvt_pk_bf16_f32 v10, v10, v11
    v_and_b32 v11, 0xffff0000, v10
    v_lshlrev_b32 v10, 16, v10
    v_cvt_pk_bf16_f32 v12, v12, v13
    v_and_b32 v13, 0xffff0000, v12
    v_lshlrev_b32 v12, 16, v12
    v_cvt_pk_bf16_f32 v14, v14, v15
    v_and_b32 v15, 0xffff0000, v14
    v_lshlrev_b32 v14, 16, v14
    v_cvt_pk_bf16_f32 v16, v16, v17
    v_and_b32 v17, 0xffff0000, v16
    v_lshlrev_b32 v16, 16, v16
    v_cvt_pk_bf16_f32 v18, v18, v19
    v_and_b32 v19, 0xffff0000, v18
    v_lshlrev_b32 v18, 16, v18
    v_cvt_pk_bf16_f32 v20, v20, v21
    v_and_b32 v21, 0xffff0000, v20
    v_lshlrev_b32 v20, 16, v20
    s_waitcnt vmcnt(13)
    v_lshlrev_b32 v96, 16, v24
    v_and_b32 v97, 0xffff0000, v24
    v_mul_f32 v100, v96, v8
    v_mul_f32 v101, v97, v8
    v_lshlrev_b32 v96, 16, v25
    v_and_b32 v97, 0xffff0000, v25
    v_mul_f32 v102, v96, v8
    v_mul_f32 v103, v97, v8
    v_lshlrev_b32 v96, 16, v26
    v_and_b32 v97, 0xffff0000, v26
    v_mul_f32 v104, v96, v8
    v_mul_f32 v105, v97, v8
    v_lshlrev_b32 v96, 16, v27
    v_and_b32 v97, 0xffff0000, v27
    v_mul_f32 v106, v96, v8
    v_mul_f32 v107, v97, v8
    s_waitcnt vmcnt(12)
    v_lshlrev_b32 v96, 16, v28
    v_and_b32 v97, 0xffff0000, v28
    v_fmac_f32 v100, v96, v9
    v_fmac_f32 v101, v97, v9
    v_lshlrev_b32 v96, 16, v29
    v_and_b32 v97, 0xffff0000, v29
    v_fmac_f32 v102, v96, v9
    v_fmac_f32 v103, v97, v9
    v_lshlrev_b32 v96, 16, v30
    v_and_b32 v97, 0xffff0000, v30
    v_fmac_f32 v104, v96, v9
    v_fmac_f32 v105, v97, v9
    v_lshlrev_b32 v96, 16, v31
    v_and_b32 v97, 0xffff0000, v31
    v_fmac_f32 v106, v96, v9
    v_fmac_f32 v107, v97, v9
    s_waitcnt vmcnt(11)
    v_lshlrev_b32 v96, 16, v32
    v_and_b32 v97, 0xffff0000, v32
    v_fmac_f32 v100, v96, v10
    v_fmac_f32 v101, v97, v10
    v_lshlrev_b32 v96, 16, v33
    v_and_b32 v97, 0xffff0000, v33
    v_fmac_f32 v102, v96, v10
    v_fmac_f32 v103, v97, v10
    v_lshlrev_b32 v96, 16, v34
    v_and_b32 v97, 0xffff0000, v34
    v_fmac_f32 v104, v96, v10
    v_fmac_f32 v105, v97, v10
    v_lshlrev_b32 v96, 16, v35
    v_and_b32 v97, 0xffff0000, v35
    v_fmac_f32 v106, v96, v10
    v_fmac_f32 v107, v97, v10
    s_waitcnt vmcnt(10)
    v_lshlrev_b32 v96, 16, v36
    v_and_b32 v97, 0xffff0000, v36
    v_fmac_f32 v100, v96, v11
    v_fmac_f32 v101, v97, v11
    v_lshlrev_b32 v96, 16, v37
    v_and_b32 v97, 0xffff0000, v37
    v_fmac_f32 v102, v96, v11
    v_fmac_f32 v103, v97, v11
    v_lshlrev_b32 v96, 16, v38
    v_and_b32 v97, 0xffff0000, v38
    v_fmac_f32 v104, v96, v11
    v_fmac_f32 v105, v97, v11
    v_lshlrev_b32 v96, 16, v39
    v_and_b32 v97, 0xffff0000, v39
    v_fmac_f32 v106, v96, v11
    v_fmac_f32 v107, v97, v11
    s_waitcnt vmcnt(9)
    v_lshlrev_b32 v96, 16, v40
    v_and_b32 v97, 0xffff0000, v40
    v_fmac_f32 v100, v96, v12
    v_fmac_f32 v101, v97, v12
    v_lshlrev_b32 v96, 16, v41
    v_and_b32 v97, 0xffff0000, v41
    v_fmac_f32 v102, v96, v12
    v_fmac_f32 v103, v97, v12
    v_lshlrev_b32 v96, 16, v42
    v_and_b32 v97, 0xffff0000, v42
    v_fmac_f32 v104, v96, v12
    v_fmac_f32 v105, v97, v12
    v_lshlrev_b32 v96, 16, v43
    v_and_b32 v97, 0xffff0000, v43
    v_fmac_f32 v106, v96, v12
    v_fmac_f32 v107, v97, v12
    s_waitcnt vmcnt(8)
    v_lshlrev_b32 v96, 16, v44
    v_and_b32 v97, 0xffff0000, v44
    v_fmac_f32 v100, v96, v13
    v_fmac_f32 v101, v97, v13
    v_lshlrev_b32 v96, 16, v45
    v_and_b32 v97, 0xffff0000, v45
    v_fmac_f32 v102, v96, v13
    v_fmac_f32 v103, v97, v13
    v_lshlrev_b32 v96, 16, v46
    v_and_b32 v97, 0xffff0000, v46
    v_fmac_f32 v104, v96, v13
    v_fmac_f32 v105, v97, v13
    v_lshlrev_b32 v96, 16, v47
    v_and_b32 v97, 0xffff0000, v47
    v_fmac_f32 v106, v96, v13
    v_fmac_f32 v107, v97, v13
    s_waitcnt vmcnt(7)
    v_lshlrev_b32 v96, 16, v48
    v_and_b32 v97, 0xffff0000, v48
    v_fmac_f32 v100, v96, v14
    v_fmac_f32 v101, v97, v14
    v_lshlrev_b32 v96, 16, v49
    v_and_b32 v97, 0xffff0000, v49
    v_fmac_f32 v102, v96, v14
    v_fmac_f32 v103, v97, v14
    v_lshlrev_b32 v96, 16, v50
    v_and_b32 v97, 0xffff0000, v50
    v_fmac_f32 v104, v96, v14
    v_fmac_f32 v105, v97, v14
    v_lshlrev_b32 v96, 16, v51
    v_and_b32 v97, 0xffff0000, v51
    v_fmac_f32 v106, v96, v14
    v_fmac_f32 v107, v97, v14
    s_waitcnt vmcnt(6)
    v_lshlrev_b32 v96, 16, v52
    v_and_b32 v97, 0xffff0000, v52
    v_fmac_f32 v100, v96, v15
    v_fmac_f32 v101, v97, v15
    v_lshlrev_b32 v96, 16, v53
    v_and_b32 v97, 0xffff0000, v53
    v_fmac_f32 v102, v96, v15
    v_fmac_f32 v103, v97, v15
    v_lshlrev_b32 v96, 16, v54
    v_and_b32 v97, 0xffff0000, v54
    v_fmac_f32 v104, v96, v15
    v_fmac_f32 v105, v97, v15
    v_lshlrev_b32 v96, 16, v55
    v_and_b32 v97, 0xffff0000, v55
    v_fmac_f32 v106, v96, v15
    v_fmac_f32 v107, v97, v15
    s_waitcnt vmcnt(5)
    v_lshlrev_b32 v96, 16, v56
    v_and_b32 v97, 0xffff0000, v56
    v_fmac_f32 v100, v96, v16
    v_fmac_f32 v101, v97, v16
    v_lshlrev_b32 v96, 16, v57
    v_and_b32 v97, 0xffff0000, v57
    v_fmac_f32 v102, v96, v16
    v_fmac_f32 v103, v97, v16
    v_lshlrev_b32 v96, 16, v58
    v_and_b32 v97, 0xffff0000, v58
    v_fmac_f32 v104, v96, v16
    v_fmac_f32 v105, v97, v16
    v_lshlrev_b32 v96, 16, v59
    v_and_b32 v97, 0xffff0000, v59
    v_fmac_f32 v106, v96, v16
    v_fmac_f32 v107, v97, v16
    s_waitcnt vmcnt(4)
    v_lshlrev_b32 v96, 16, v60
    v_and_b32 v97, 0xffff0000, v60
    v_fmac_f32 v100, v96, v17
    v_fmac_f32 v101, v97, v17
    v_lshlrev_b32 v96, 16, v61
    v_and_b32 v97, 0xffff0000, v61
    v_fmac_f32 v102, v96, v17
    v_fmac_f32 v103, v97, v17
    v_lshlrev_b32 v96, 16, v62
    v_and_b32 v97, 0xffff0000, v62
    v_fmac_f32 v104, v96, v17
    v_fmac_f32 v105, v97, v17
    v_lshlrev_b32 v96, 16, v63
    v_and_b32 v97, 0xffff0000, v63
    v_fmac_f32 v106, v96, v17
    v_fmac_f32 v107, v97, v17
    s_waitcnt vmcnt(3)
    v_lshlrev_b32 v96, 16, v64
    v_and_b32 v97, 0xffff0000, v64
    v_fmac_f32 v100, v96, v18
    v_fmac_f32 v101, v97, v18
    v_lshlrev_b32 v96, 16, v65
    v_and_b32 v97, 0xffff0000, v65
    v_fmac_f32 v102, v96, v18
    v_fmac_f32 v103, v97, v18
    v_lshlrev_b32 v96, 16, v66
    v_and_b32 v97, 0xffff0000, v66
    v_fmac_f32 v104, v96, v18
    v_fmac_f32 v105, v97, v18
    v_lshlrev_b32 v96, 16, v67
    v_and_b32 v97, 0xffff0000, v67
    v_fmac_f32 v106, v96, v18
    v_fmac_f32 v107, v97, v18
    s_waitcnt vmcnt(2)
    v_lshlrev_b32 v96, 16, v68
    v_and_b32 v97, 0xffff0000, v68
    v_fmac_f32 v100, v96, v19
    v_fmac_f32 v101, v97, v19
    v_lshlrev_b32 v96, 16, v69
    v_and_b32 v97, 0xffff0000, v69
    v_fmac_f32 v102, v96, v19
    v_fmac_f32 v103, v97, v19
    v_lshlrev_b32 v96, 16, v70
    v_and_b32 v97, 0xffff0000, v70
    v_fmac_f32 v104, v96, v19
    v_fmac_f32 v105, v97, v19
    v_lshlrev_b32 v96, 16, v71
    v_and_b32 v97, 0xffff0000, v71
    v_fmac_f32 v106, v96, v19
    v_fmac_f32 v107, v97, v19
    s_waitcnt vmcnt(1)
    v_lshlrev_b32 v96, 16, v72
    v_and_b32 v97, 0xffff0000, v72
    v_fmac_f32 v100, v96, v20
    v_fmac_f32 v101, v97, v20
    v_lshlrev_b32 v96, 16, v73
    v_and_b32 v97, 0xffff0000, v73
    v_fmac_f32 v102, v96, v20
    v_fmac_f32 v103, v97, v20
    v_lshlrev_b32 v96, 16, v74
    v_and_b32 v97, 0xffff0000, v74
    v_fmac_f32 v104, v96, v20
    v_fmac_f32 v105, v97, v20
    v_lshlrev_b32 v96, 16, v75
    v_and_b32 v97, 0xffff0000, v75
    v_fmac_f32 v106, v96, v20
    v_fmac_f32 v107, v97, v20
    s_waitcnt vmcnt(0)
    v_lshlrev_b32 v96, 16, v76
    v_and_b32 v97, 0xffff0000, v76
    v_fmac_f32 v100, v96, v21
    v_fmac_f32 v101, v97, v21
    v_lshlrev_b32 v96, 16, v77
    v_and_b32 v97, 0xffff0000, v77
    v_fmac_f32 v102, v96, v21
    v_fmac_f32 v103, v97, v21
    v_lshlrev_b32 v96, 16, v78
    v_and_b32 v97, 0xffff0000, v78
    v_fmac_f32 v104, v96, v21
    v_fmac_f32 v105, v97, v21
    v_lshlrev_b32 v96, 16, v79
    v_and_b32 v97, 0xffff0000, v79
    v_fmac_f32 v106, v96, v21
    v_fmac_f32 v107, v97, v21
    v_add_f32 v100, v100, v100 row_ror:8 row_mask:0xf bank_mask:0xf
    v_add_f32 v101, v101, v101 row_ror:8 row_mask:0xf bank_mask:0xf
    v_add_f32 v102, v102, v102 row_ror:8 row_mask:0xf bank_mask:0xf
    v_add_f32 v103, v103, v103 row_ror:8 row_mask:0xf bank_mask:0xf
    v_add_f32 v104, v104, v104 row_ror:8 row_mask:0xf bank_mask:0xf
    v_add_f32 v105, v105, v105 row_ror:8 row_mask:0xf bank_mask:0xf
    v_add_f32 v106, v106, v106 row_ror:8 row_mask:0xf bank_mask:0xf
    v_add_f32 v107, v107, v107 row_ror:8 row_mask:0xf bank_mask:0xf
    v_mov_b32 v110, v100
    v_mov_b32 v111, v101
    v_mov_b32 v112, v102
    v_mov_b32 v113, v103
    v_mov_b32 v114, v104
    v_mov_b32 v115, v105
    v_mov_b32 v116, v106
    v_mov_b32 v117, v107
    v_permlane32_swap_b32 v100, v110
    v_permlane32_swap_b32 v101, v111
    v_permlane32_swap_b32 v102, v112
    v_permlane32_swap_b32 v103, v113
    v_permlane32_swap_b32 v104, v114
    v_permlane32_swap_b32 v105, v115
    v_permlane32_swap_b32 v106, v116
    v_permlane32_swap_b32 v107, v117
    v_add_f32 v100, v100, v110
    v_add_f32 v101, v101, v111
    v_add_f32 v102, v102, v112
    v_add_f32 v103, v103, v113
    v_add_f32 v104, v104, v114
    v_add_f32 v105, v105, v115
    v_add_f32 v106, v106, v116
    v_add_f32 v107, v107, v117
    v_mov_b32 v110, v100
    v_mov_b32 v111, v101
    v_mov_b32 v112, v102
    v_mov_b32 v113, v103
    v_mov_b32 v114, v104
    v_mov_b32 v115, v105
    v_mov_b32 v116, v106
    v_mov_b32 v117, v107
    v_permlane16_swap_b32 v100, v110
    v_permlane16_swap_b32 v101, v111
    v_permlane16_swap_b32 v102, v112
    v_permlane16_swap_b32 v103, v113
    v_permlane16_swap_b32 v104, v114
    v_permlane16_swap_b32 v105, v115
    v_permlane16_swap_b32 v106, v116
    v_permlane16_swap_b32 v107, v117
    v_add_f32 v100, v100, v110
    v_add_f32 v101, v101, v111
    v_add_f32 v102, v102, v112
    v_add_f32 v103, v103, v113
    v_add_f32 v104, v104, v114
    v_add_f32 v105, v105, v115
    v_add_f32 v106, v106, v116
    v_add_f32 v107, v107, v117
    s_mul_i32 s12, s37, 10752
    s_lshl_b32 s13, s36, 8
    s_add_u32 s12, s12, s13
    v_lshlrev_b32 v3, 5, v1
    v_bfrev_b32 v4, 1
    v_cmp_gt_u32 vcc, 8, v1
    s_nop 1
    v_cndmask_b32 v3, v4, v3, vcc
    buffer_store_dwordx4 v[100:103], v3, s[24:27], s12 offen sc1
    buffer_store_dwordx4 v[104:107], v3, s[24:27], s12 offen offset:16 sc1
    s_waitcnt vmcnt(0)
    s_and_b32 s29, s2, 3
    s_lshl_b32 s29, s29, 6
    v_mov_b32 v8, 1
    v_cmp_eq_u32 vcc, 0, v1
    v_bfrev_b32 v10, 1
    s_nop 0
    v_cndmask_b32 v9, v10, 0, vcc
    buffer_atomic_add v8, v9, s[32:35], s29 offen sc0
    s_waitcnt vmcnt(0)
    v_readfirstlane_b32 s30, v8
    s_nop 0
    s_cmp_lg_u32 s30, 105
    s_cbranch_scc1 KA_end
    v_not_b32 v12, v120
    buffer_store_dword v12, v121, s[44:47], 0 offen sc1
KA_end:
    s_endpgm
.globl k3_kernel
.p2align 8
.type k3_kernel,@function
k3_kernel:
    s_cmp_ge_u32 s2, 256
    s_cbranch_scc1 K3_end
    s_and_b32 s56, s2, 7
    s_lshr_b32 s57, s2, 5
    s_lshl_b32 s57, s57, 3
    s_add_u32 s56, s56, s57
    s_lshl_b32 s56, s56, 2
    s_bfe_u32 s57, s2, 0x20003
    s_add_u32 s2, s56, s57
    s_load_dwordx2 s[4:5], s[0:1], 144
    s_load_dwordx2 s[6:7], s[0:1], 0
    s_load_dwordx2 s[8:9], s[0:1], 80
    s_load_dwordx2 s[10:11], s[0:1], 128
    v_and_b32 v1, 7, v0
    v_bfe_u32 v2, v0, 3, 3
    v_lshrrev_b32 v3, 6, v0
    v_lshl_add_u32 v4, v3, 3, v1
    s_lshl_b32 s12, s2, 3
    v_add_u32 v5, s12, v2
    s_movk_i32 s13, 896
    v_mul_lo_u32 v6, v5, s13
    v_lshl_add_u32 v6, v4, 4, v6
    v_lshlrev_b32 v7, 15, v4
    v_lshl_add_u32 v7, v5, 2, v7
    v_lshlrev_b32 v8, 4, v4
    s_waitcnt lgkmcnt(0)
    s_mov_b32 s16, s6
    s_mov_b32 s17, s7
    s_mov_b32 s18, 1835008
    s_mov_b32 s19, 0x00020000
    s_add_u32 s20, s4, 4194304
    s_addc_u32 s21, s5, 0
    s_mov_b32 s22, 1835008
    s_mov_b32 s23, 0x00020000
    s_mov_b32 s24, s4
    s_mov_b32 s25, s5
    s_mov_b32 s26, 5376
    s_mov_b32 s27, 0x00020000
    s_mov_b32 s28, s8
    s_mov_b32 s29, s9
    s_mov_b32 s30, 896
    s_mov_b32 s31, 0x00020000
    s_mov_b32 s32, s10
    s_mov_b32 s33, s11
    s_mov_b32 s34, 1835008
    s_mov_b32 s35, 0x00020000
    s_add_u32 s36, s4, 6291456
    s_addc_u32 s37, s5, 0
    s_mov_b32 s38, 1835008
    s_mov_b32 s39, 0x00020000
    s_add_u32 s40, s4, 16384
    s_addc_u32 s41, s5, 0
    s_mov_b32 s42, 24576
    s_mov_b32 s43, 0x00020000
    s_add_u32 s52, s4, 16777216
    s_addc_u32 s53, s5, 0
    s_mov_b32 s54, 1835008
    s_mov_b32 s55, 0x00020000
    buffer_load_dwordx4 v[12:15], v6, s[16:19], 0 offen
    s_mov_b32 s14, 0
    buffer_load_dword v16, v7, s[20:23], s14 offen
    s_mov_b32 s14, 8192
    buffer_load_dword v17, v7, s[20:23], s14 offen
    s_mov_b32 s14, 16384
    buffer_load_dword v18, v7, s[20:23], s14 offen
    s_mov_b32 s14, 24576
    buffer_load_dword v19, v7, s[20:23], s14 offen
    buffer_load_dwordx4 v[20:23], v8, s[24:27], 0 offen offset:1792
    buffer_load_dwordx4 v[24:27], v8, s[24:27], 0 offen offset:3584
    buffer_load_dwordx4 v[28:31], v8, s[24:27], 0 offen offset:2688
    s_movk_i32 s14, 4480
    buffer_load_dwordx4 v[32:35], v8, s[24:27], s14 offen
    buffer_load_dwordx4 v[36:39], v8, s[28:31], 0 offen
    s_mov_b32 s44, 1015021568
    s_mov_b32 s45, 1041385765
    s_mov_b32 s46, 1115684864
    s_mov_b32 s47, 991054117
    s_mov_b32 s48, 925353388
    v_lshlrev_b32 v9, 6, v2
    v_lshl_add_u32 v10, v3, 3, v9
    s_waitcnt vmcnt(4)
    v_lshlrev_b32 v40, 16, v16
    v_and_b32 v41, 0xffff0000, v16
    v_lshlrev_b32 v60, 16, v20
    v_and_b32 v61, 0xffff0000, v20
    v_pk_mul_f32 v[40:41], v[40:41], v[60:61]
    v_cvt_pk_bf16_f32 v40, v40, v41
    v_and_b32 v41, 0xffff0000, v40
    v_lshlrev_b32 v40, 16, v40
    v_lshlrev_b32 v60, 16, v12
    v_and_b32 v61, 0xffff0000, v12
    v_pk_add_f32 v[40:41], v[40:41], v[60:61]
    v_cvt_pk_bf16_f32 v48, v40, v41
    v_lshlrev_b32 v40, 16, v48
    v_and_b32 v41, 0xffff0000, v48
    v_lshlrev_b32 v42, 16, v17
    v_and_b32 v43, 0xffff0000, v17
    v_lshlrev_b32 v60, 16, v21
    v_and_b32 v61, 0xffff0000, v21
    v_pk_mul_f32 v[42:43], v[42:43], v[60:61]
    v_cvt_pk_bf16_f32 v42, v42, v43
    v_and_b32 v43, 0xffff0000, v42
    v_lshlrev_b32 v42, 16, v42
    v_lshlrev_b32 v60, 16, v13
    v_and_b32 v61, 0xffff0000, v13
    v_pk_add_f32 v[42:43], v[42:43], v[60:61]
    v_cvt_pk_bf16_f32 v49, v42, v43
    v_lshlrev_b32 v42, 16, v49
    v_and_b32 v43, 0xffff0000, v49
    v_lshlrev_b32 v44, 16, v18
    v_and_b32 v45, 0xffff0000, v18
    v_lshlrev_b32 v60, 16, v22
    v_and_b32 v61, 0xffff0000, v22
    v_pk_mul_f32 v[44:45], v[44:45], v[60:61]
    v_cvt_pk_bf16_f32 v44, v44, v45
    v_and_b32 v45, 0xffff0000, v44
    v_lshlrev_b32 v44, 16, v44
    v_lshlrev_b32 v60, 16, v14
    v_and_b32 v61, 0xffff0000, v14
    v_pk_add_f32 v[44:45], v[44:45], v[60:61]
    v_cvt_pk_bf16_f32 v50, v44, v45
    v_lshlrev_b32 v44, 16, v50
    v_and_b32 v45, 0xffff0000, v50
    v_lshlrev_b32 v46, 16, v19
    v_and_b32 v47, 0xffff0000, v19
    v_lshlrev_b32 v60, 16, v23
    v_and_b32 v61, 0xffff0000, v23
    v_pk_mul_f32 v[46:47], v[46:47], v[60:61]
    v_cvt_pk_bf16_f32 v46, v46, v47
    v_and_b32 v47, 0xffff0000, v46
    v_lshlrev_b32 v46, 16, v46
    v_lshlrev_b32 v60, 16, v15
    v_and_b32 v61, 0xffff0000, v15
    v_pk_add_f32 v[46:47], v[46:47], v[60:61]
    v_cvt_pk_bf16_f32 v51, v46, v47
    v_lshlrev_b32 v46, 16, v51
    v_and_b32 v47, 0xffff0000, v51
    buffer_store_dwordx4 v[48:51], v6, s[36:39], 0 offen sc1
    v_add_f32 v52, v40, v41
    v_add_f32 v53, v42, v43
    v_add_f32 v54, v44, v45
    v_add_f32 v55, v46, v47
    v_add_f32 v52, v52, v53
    v_add_f32 v54, v54, v55
    v_add_f32 v52, v52, v54
    s_nop 1
    v_add_f32 v52, v52, v52 quad_perm:[1,0,3,2] row_mask:0xf bank_mask:0xf
    s_nop 1
    v_add_f32 v52, v52, v52 quad_perm:[2,3,0,1] row_mask:0xf bank_mask:0xf
    s_nop 1
    v_add_f32 v52, v52, v52 row_half_mirror row_mask:0xf bank_mask:0xf
    v_mul_f32 v52, s44, v52
    v_sub_f32 v54, v40, v52
    v_mul_f32 v53, v54, v54
    v_sub_f32 v54, v41, v52
    v_fmac_f32 v53, v54, v54
    v_sub_f32 v54, v42, v52
    v_fmac_f32 v53, v54, v54
    v_sub_f32 v54, v43, v52
    v_fmac_f32 v53, v54, v54
    v_sub_f32 v54, v44, v52
    v_fmac_f32 v53, v54, v54
    v_sub_f32 v54, v45, v52
    v_fmac_f32 v53, v54, v54
    v_sub_f32 v54, v46, v52
    v_fmac_f32 v53, v54, v54
    v_sub_f32 v54, v47, v52
    v_fmac_f32 v53, v54, v54
    s_nop 1
    v_add_f32 v53, v53, v53 quad_perm:[1,0,3,2] row_mask:0xf bank_mask:0xf
    s_nop 1
    v_add_f32 v53, v53, v53 quad_perm:[2,3,0,1] row_mask:0xf bank_mask:0xf
    s_nop 1
    v_add_f32 v53, v53, v53 row_half_mirror row_mask:0xf bank_mask:0xf
    ds_write_b64 v10, v[52:53]
    s_waitcnt lgkmcnt(0)
    s_barrier
    ds_read_b128 v[64:67], v9
    ds_read_b128 v[68:71], v9 offset:16
    ds_read_b128 v[72:75], v9 offset:32
    ds_read_b64 v[76:77], v9 offset:48
    s_waitcnt vmcnt(1)
    v_lshlrev_b32 v80, 16, v24
    v_and_b32 v81, 0xffff0000, v24
    v_pk_add_f32 v[80:81], v[80:81], 1.0 op_sel_hi:[1,0]
    v_cvt_pk_bf16_f32 v80, v80, v81
    v_and_b32 v81, 0xffff0000, v80
    v_lshlrev_b32 v80, 16, v80
    v_lshlrev_b32 v88, 16, v28
    v_and_b32 v89, 0xffff0000, v28
    v_lshlrev_b32 v82, 16, v25
    v_and_b32 v83, 0xffff0000, v25
    v_pk_add_f32 v[82:83], v[82:83], 1.0 op_sel_hi:[1,0]
    v_cvt_pk_bf16_f32 v82, v82, v83
    v_and_b32 v83, 0xffff0000, v82
    v_lshlrev_b32 v82, 16, v82
    v_lshlrev_b32 v90, 16, v29
    v_and_b32 v91, 0xffff0000, v29
    v_lshlrev_b32 v84, 16, v26
    v_and_b32 v85, 0xffff0000, v26
    v_pk_add_f32 v[84:85], v[84:85], 1.0 op_sel_hi:[1,0]
    v_cvt_pk_bf16_f32 v84, v84, v85
    v_and_b32 v85, 0xffff0000, v84
    v_lshlrev_b32 v84, 16, v84
    v_lshlrev_b32 v92, 16, v30
    v_and_b32 v93, 0xffff0000, v30
    v_lshlrev_b32 v86, 16, v27
    v_and_b32 v87, 0xffff0000, v27
    v_pk_add_f32 v[86:87], v[86:87], 1.0 op_sel_hi:[1,0]
    v_cvt_pk_bf16_f32 v86, v86, v87
    v_and_b32 v87, 0xffff0000, v86
    v_lshlrev_b32 v86, 16, v86
    v_lshlrev_b32 v94, 16, v31
    v_and_b32 v95, 0xffff0000, v31
    s_waitcnt lgkmcnt(0)
    v_add_f32 v52, v64, v66
    v_add_f32 v53, v68, v70
    v_add_f32 v54, v72, v74
    v_add_f32 v52, v52, v76
    v_add_f32 v52, v52, v53
    v_add_f32 v52, v52, v54
    v_mul_f32 v52, s45, v52
    v_add_f32 v53, v65, v67
    v_add_f32 v54, v69, v71
    v_add_f32 v55, v73, v75
    v_add_f32 v53, v53, v77
    v_add_f32 v53, v53, v54
    v_add_f32 v53, v53, v55
    v_sub_f32 v55, v64, v52
    v_mul_f32 v54, v55, v55
    v_sub_f32 v55, v66, v52
    v_fmac_f32 v54, v55, v55
    v_sub_f32 v55, v68, v52
    v_fmac_f32 v54, v55, v55
    v_sub_f32 v55, v70, v52
    v_fmac_f32 v54, v55, v55
    v_sub_f32 v55, v72, v52
    v_fmac_f32 v54, v55, v55
    v_sub_f32 v55, v74, v52
    v_fmac_f32 v54, v55, v55
    v_sub_f32 v55, v76, v52
    v_fmac_f32 v54, v55, v55
    v_fmac_f32 v53, s46, v54
    v_mul_f32 v53, s47, v53
    v_cvt_pk_bf16_f32 v56, v52, v52
    v_and_b32 v56, 0xffff0000, v56
    v_cvt_pk_bf16_f32 v53, v53, v53
    v_and_b32 v53, 0xffff0000, v53
    v_add_f32 v53, s48, v53
    v_cvt_pk_bf16_f32 v53, v53, v53
    v_and_b32 v53, 0xffff0000, v53
    v_sqrt_f32 v53, v53
    s_nop 0
    v_cvt_pk_bf16_f32 v53, v53, v53
    v_and_b32 v53, 0xffff0000, v53
    v_rcp_f32 v57, v53
    v_mov_b32 v58, v56
    v_mov_b32 v59, v57
    v_mov_b32 v100, v56
    v_mov_b32 v101, v56
    v_mov_b32 v102, v57
    v_mov_b32 v103, v57
    v_pk_add_f32 v[104:105], v[40:41], v[100:101] neg_lo:[0,1] neg_hi:[0,1]
    v_cvt_pk_bf16_f32 v104, v104, v105
    v_and_b32 v105, 0xffff0000, v104
    v_lshlrev_b32 v104, 16, v104
    v_pk_mul_f32 v[104:105], v[104:105], v[102:103]
    v_cvt_pk_bf16_f32 v104, v104, v105
    v_and_b32 v105, 0xffff0000, v104
    v_lshlrev_b32 v104, 16, v104
    v_pk_mul_f32 v[104:105], v[104:105], v[80:81]
    v_cvt_pk_bf16_f32 v104, v104, v105
    v_and_b32 v105, 0xffff0000, v104
    v_lshlrev_b32 v104, 16, v104
    v_pk_add_f32 v[104:105], v[104:105], v[88:89]
    v_cvt_pk_bf16_f32 v116, v104, v105
    v_lshlrev_b32 v104, 16, v116
    v_and_b32 v105, 0xffff0000, v116
    v_lshlrev_b32 v60, 16, v36
    v_and_b32 v61, 0xffff0000, v36
    v_mul_f32 v62, v104, v60
    v_mul_f32 v63, v105, v61
    v_lshlrev_b32 v60, 16, v32
    v_and_b32 v61, 0xffff0000, v32
    v_pk_mul_f32 v[60:61], v[60:61], v[104:105]
    v_cvt_pk_bf16_f32 v60, v60, v61
    v_and_b32 v61, 0xffff0000, v60
    v_lshlrev_b32 v60, 16, v60
    v_pk_add_f32 v[60:61], v[60:61], v[40:41]
    v_cvt_pk_bf16_f32 v112, v60, v61
    v_pk_add_f32 v[106:107], v[42:43], v[100:101] neg_lo:[0,1] neg_hi:[0,1]
    v_cvt_pk_bf16_f32 v106, v106, v107
    v_and_b32 v107, 0xffff0000, v106
    v_lshlrev_b32 v106, 16, v106
    v_pk_mul_f32 v[106:107], v[106:107], v[102:103]
    v_cvt_pk_bf16_f32 v106, v106, v107
    v_and_b32 v107, 0xffff0000, v106
    v_lshlrev_b32 v106, 16, v106
    v_pk_mul_f32 v[106:107], v[106:107], v[82:83]
    v_cvt_pk_bf16_f32 v106, v106, v107
    v_and_b32 v107, 0xffff0000, v106
    v_lshlrev_b32 v106, 16, v106
    v_pk_add_f32 v[106:107], v[106:107], v[90:91]
    v_cvt_pk_bf16_f32 v117, v106, v107
    v_lshlrev_b32 v106, 16, v117
    v_and_b32 v107, 0xffff0000, v117
    v_lshlrev_b32 v60, 16, v37
    v_and_b32 v61, 0xffff0000, v37
    v_fmac_f32 v62, v106, v60
    v_fmac_f32 v63, v107, v61
    v_lshlrev_b32 v60, 16, v33
    v_and_b32 v61, 0xffff0000, v33
    v_pk_mul_f32 v[60:61], v[60:61], v[106:107]
    v_cvt_pk_bf16_f32 v60, v60, v61
    v_and_b32 v61, 0xffff0000, v60
    v_lshlrev_b32 v60, 16, v60
    v_pk_add_f32 v[60:61], v[60:61], v[42:43]
    v_cvt_pk_bf16_f32 v113, v60, v61
    v_pk_add_f32 v[108:109], v[44:45], v[100:101] neg_lo:[0,1] neg_hi:[0,1]
    v_cvt_pk_bf16_f32 v108, v108, v109
    v_and_b32 v109, 0xffff0000, v108
    v_lshlrev_b32 v108, 16, v108
    v_pk_mul_f32 v[108:109], v[108:109], v[102:103]
    v_cvt_pk_bf16_f32 v108, v108, v109
    v_and_b32 v109, 0xffff0000, v108
    v_lshlrev_b32 v108, 16, v108
    v_pk_mul_f32 v[108:109], v[108:109], v[84:85]
    v_cvt_pk_bf16_f32 v108, v108, v109
    v_and_b32 v109, 0xffff0000, v108
    v_lshlrev_b32 v108, 16, v108
    v_pk_add_f32 v[108:109], v[108:109], v[92:93]
    v_cvt_pk_bf16_f32 v118, v108, v109
    v_lshlrev_b32 v108, 16, v118
    v_and_b32 v109, 0xffff0000, v118
    v_lshlrev_b32 v60, 16, v38
    v_and_b32 v61, 0xffff0000, v38
    v_fmac_f32 v62, v108, v60
    v_fmac_f32 v63, v109, v61
    v_lshlrev_b32 v60, 16, v34
    v_and_b32 v61, 0xffff0000, v34
    v_pk_mul_f32 v[60:61], v[60:61], v[108:109]
    v_cvt_pk_bf16_f32 v60, v60, v61
    v_and_b32 v61, 0xffff0000, v60
    v_lshlrev_b32 v60, 16, v60
    v_pk_add_f32 v[60:61], v[60:61], v[44:45]
    v_cvt_pk_bf16_f32 v114, v60, v61
    v_pk_add_f32 v[110:111], v[46:47], v[100:101] neg_lo:[0,1] neg_hi:[0,1]
    v_cvt_pk_bf16_f32 v110, v110, v111
    v_and_b32 v111, 0xffff0000, v110
    v_lshlrev_b32 v110, 16, v110
    v_pk_mul_f32 v[110:111], v[110:111], v[102:103]
    v_cvt_pk_bf16_f32 v110, v110, v111
    v_and_b32 v111, 0xffff0000, v110
    v_lshlrev_b32 v110, 16, v110
    v_pk_mul_f32 v[110:111], v[110:111], v[86:87]
    v_cvt_pk_bf16_f32 v110, v110, v111
    v_and_b32 v111, 0xffff0000, v110
    v_lshlrev_b32 v110, 16, v110
    v_pk_add_f32 v[110:111], v[110:111], v[94:95]
    v_cvt_pk_bf16_f32 v119, v110, v111
    v_lshlrev_b32 v110, 16, v119
    v_and_b32 v111, 0xffff0000, v119
    v_lshlrev_b32 v60, 16, v39
    v_and_b32 v61, 0xffff0000, v39
    v_fmac_f32 v62, v110, v60
    v_fmac_f32 v63, v111, v61
    v_lshlrev_b32 v60, 16, v35
    v_and_b32 v61, 0xffff0000, v35
    v_pk_mul_f32 v[60:61], v[60:61], v[110:111]
    v_cvt_pk_bf16_f32 v60, v60, v61
    v_and_b32 v61, 0xffff0000, v60
    v_lshlrev_b32 v60, 16, v60
    v_pk_add_f32 v[60:61], v[60:61], v[46:47]
    v_cvt_pk_bf16_f32 v115, v60, v61
    buffer_store_dwordx4 v[112:115], v6, s[32:35], 0 offen sc1
    buffer_store_dwordx4 v[116:119], v6, s[52:55], 0 offen sc1
    v_add_f32 v62, v62, v63
    s_nop 1
    v_add_f32 v62, v62, v62 quad_perm:[1,0,3,2] row_mask:0xf bank_mask:0xf
    s_nop 1
    v_add_f32 v62, v62, v62 quad_perm:[2,3,0,1] row_mask:0xf bank_mask:0xf
    s_nop 1
    v_add_f32 v62, v62, v62 row_half_mirror row_mask:0xf bank_mask:0xf
    v_lshlrev_b32 v9, 5, v2
    v_lshl_add_u32 v10, v3, 2, v9
    ds_write_b32 v10, v62 offset:512
    s_waitcnt lgkmcnt(0)
    s_barrier
    v_cmp_gt_u32 vcc, 64, v0
    s_nop 0
    s_and_saveexec_b64 s[50:51], vcc
    s_cbranch_execz K3_end
    ds_read_b128 v[64:67], v9 offset:512
    ds_read_b96 v[68:70], v9 offset:528
    v_cmp_eq_u32 vcc, 0, v1
    v_lshlrev_b32 v11, 2, v5
    v_lshlrev_b32 v12, 3, v5
    v_bfrev_b32 v13, 1
    v_cndmask_b32 v11, v13, v11, vcc
    v_cndmask_b32 v12, v13, v12, vcc
    s_movk_i32 s14, 0x2000
    s_waitcnt lgkmcnt(0)
    v_add_f32 v64, v64, v65
    v_add_f32 v66, v66, v67
    v_add_f32 v68, v68, v69
    v_add_f32 v64, v64, v66
    v_add_f32 v68, v68, v70
    v_add_f32 v64, v64, v68
    v_cvt_pk_bf16_f32 v64, v64, v64
    v_and_b32 v64, 0xffff0000, v64
    v_ashrrev_i32 v65, 31, v64
    v_or_b32 v65, 0x80000000, v65
    v_xor_b32 v64, v64, v65
    v_and_b32 v64, 0xffff0000, v64
    v_sub_u32 v65, 2047, v5
    v_or_b32 v64, v64, v65
    buffer_store_dword v64, v11, s[40:43], 0 offen sc1
K3_end:
    s_endpgm
.globl k4_kernel
.p2align 8
.type k4_kernel,@function
k4_kernel:
    s_cmp_ge_u32 s2, 112
    s_cbranch_scc1 K4_end
    s_load_dwordx2 s[4:5], s[0:1], 144
    s_load_dwordx2 s[6:7], s[0:1], 104
    v_lshrrev_b32 v4, 6, v0
    s_nop 0
    v_readfirstlane_b32 s3, v4
    s_nop 0
    s_cmp_ge_u32 s3, 4
    s_cbranch_scc1 K4_main
    v_mov_b32 v6, v0
    v_and_b32 v1, 63, v0
    v_lshlrev_b32 v5, 5, v6
    s_waitcnt lgkmcnt(0)
    s_add_u32 s16, s4, 16384
    s_addc_u32 s17, s5, 0
    s_mov_b32 s18, 0x6000
    s_mov_b32 s19, 0x00020000
    buffer_load_dwordx4 v[8:11], v5, s[16:19], 0 offen
    buffer_load_dwordx4 v[12:15], v5, s[16:19], 0 offen offset:16
    s_waitcnt vmcnt(0)
    v_max_u32 v18, v8, v9
    v_min_u32 v9, v8, v9
    v_max_u32 v19, v10, v11
    v_min_u32 v11, v10, v11
    v_max_u32 v20, v12, v13
    v_min_u32 v13, v12, v13
    v_max_u32 v21, v14, v15
    v_min_u32 v15, v14, v15
    v_max_u32 v22, v18, v19
    v_min_u32 v19, v18, v19
    v_max_u32 v23, v9, v11
    v_min_u32 v11, v9, v11
    v_max_u32 v24, v20, v21
    v_min_u32 v21, v20, v21
    v_max_u32 v25, v13, v15
    v_min_u32 v15, v13, v15
    v_max_u32 v26, v23, v19
    v_min_u32 v19, v23, v19
    v_max_u32 v27, v25, v21
    v_min_u32 v21, v25, v21
    v_max_u32 v28, v22, v24
    v_min_u32 v24, v22, v24
    v_max_u32 v29, v11, v15
    v_min_u32 v15, v11, v15
    v_max_u32 v30, v26, v27
    v_min_u32 v27, v26, v27
    v_max_u32 v31, v19, v21
    v_min_u32 v21, v19, v21
    v_max_u32 v32, v30, v24
    v_min_u32 v24, v30, v24
    v_max_u32 v33, v29, v21
    v_min_u32 v21, v29, v21
    v_max_u32 v34, v31, v24
    v_min_u32 v24, v31, v24
    v_max_u32 v35, v33, v27
    v_min_u32 v27, v33, v27
    v_max_u32 v36, v35, v24
    v_min_u32 v24, v35, v24
    v_max_u32 v37, v15, v28 quad_perm:[1,0,3,2] row_mask:0xf bank_mask:0xf
    v_max_u32 v38, v21, v32 quad_perm:[1,0,3,2] row_mask:0xf bank_mask:0xf
    v_max_u32 v39, v27, v34 quad_perm:[1,0,3,2] row_mask:0xf bank_mask:0xf
    v_max_u32 v8, v24, v36 quad_perm:[1,0,3,2] row_mask:0xf bank_mask:0xf
    v_max_u32 v10, v36, v24 quad_perm:[1,0,3,2] row_mask:0xf bank_mask:0xf
    v_max_u32 v12, v34, v27 quad_perm:[1,0,3,2] row_mask:0xf bank_mask:0xf
    v_max_u32 v14, v32, v21 quad_perm:[1,0,3,2] row_mask:0xf bank_mask:0xf
    v_max_u32 v18, v28, v15 quad_perm:[1,0,3,2] row_mask:0xf bank_mask:0xf
    v_max_u32 v9, v37, v10
    v_min_u32 v10, v37, v10
    v_max_u32 v20, v38, v12
    v_min_u32 v12, v38, v12
    v_max_u32 v13, v39, v14
    v_min_u32 v14, v39, v14
    v_max_u32 v23, v8, v18
    v_min_u32 v18, v8, v18
    v_max_u32 v25, v9, v13
    v_min_u32 v13, v9, v13
    v_max_u32 v22, v20, v23
    v_min_u32 v23, v20, v23
    v_max_u32 v11, v10, v14
    v_min_u32 v14, v10, v14
    v_max_u32 v26, v12, v18
    v_min_u32 v18, v12, v18
    v_max_u32 v19, v25, v22
    v_min_u32 v22, v25, v22
    v_max_u32 v30, v13, v23
    v_min_u32 v23, v13, v23
    v_max_u32 v29, v11, v26
    v_min_u32 v26, v11, v26
    v_max_u32 v31, v14, v18
    v_min_u32 v18, v14, v18
    s_nop 1
    v_max_u32 v33, v18, v19 quad_perm:[2,3,0,1] row_mask:0xf bank_mask:0xf
    v_max_u32 v35, v31, v22 quad_perm:[2,3,0,1] row_mask:0xf bank_mask:0xf
    v_max_u32 v28, v26, v30 quad_perm:[2,3,0,1] row_mask:0xf bank_mask:0xf
    v_max_u32 v32, v29, v23 quad_perm:[2,3,0,1] row_mask:0xf bank_mask:0xf
    v_max_u32 v34, v23, v29 quad_perm:[2,3,0,1] row_mask:0xf bank_mask:0xf
    v_max_u32 v36, v30, v26 quad_perm:[2,3,0,1] row_mask:0xf bank_mask:0xf
    v_max_u32 v24, v22, v31 quad_perm:[2,3,0,1] row_mask:0xf bank_mask:0xf
    v_max_u32 v27, v19, v18 quad_perm:[2,3,0,1] row_mask:0xf bank_mask:0xf
    v_max_u32 v21, v33, v34
    v_min_u32 v34, v33, v34
    v_max_u32 v15, v35, v36
    v_min_u32 v36, v35, v36
    v_max_u32 v37, v28, v24
    v_min_u32 v24, v28, v24
    v_max_u32 v38, v32, v27
    v_min_u32 v27, v32, v27
    v_max_u32 v39, v21, v37
    v_min_u32 v37, v21, v37
    v_max_u32 v8, v15, v38
    v_min_u32 v38, v15, v38
    v_max_u32 v9, v34, v24
    v_min_u32 v24, v34, v24
    v_max_u32 v20, v36, v27
    v_min_u32 v27, v36, v27
    v_max_u32 v10, v39, v8
    v_min_u32 v8, v39, v8
    v_max_u32 v12, v37, v38
    v_min_u32 v38, v37, v38
    v_max_u32 v25, v9, v20
    v_min_u32 v20, v9, v20
    v_max_u32 v13, v24, v27
    v_min_u32 v27, v24, v27
    s_nop 1
    v_max_u32 v11, v27, v10 row_half_mirror row_mask:0xf bank_mask:0xf
    v_max_u32 v14, v13, v8 row_half_mirror row_mask:0xf bank_mask:0xf
    v_max_u32 v19, v20, v12 row_half_mirror row_mask:0xf bank_mask:0xf
    v_max_u32 v22, v25, v38 row_half_mirror row_mask:0xf bank_mask:0xf
    v_max_u32 v30, v38, v25 row_half_mirror row_mask:0xf bank_mask:0xf
    v_max_u32 v23, v12, v20 row_half_mirror row_mask:0xf bank_mask:0xf
    v_max_u32 v29, v8, v13 row_half_mirror row_mask:0xf bank_mask:0xf
    v_max_u32 v26, v10, v27 row_half_mirror row_mask:0xf bank_mask:0xf
    v_max_u32 v31, v11, v30
    v_min_u32 v30, v11, v30
    v_max_u32 v18, v14, v23
    v_min_u32 v23, v14, v23
    v_max_u32 v33, v19, v29
    v_min_u32 v29, v19, v29
    v_max_u32 v35, v22, v26
    v_min_u32 v26, v22, v26
    v_max_u32 v28, v31, v33
    v_min_u32 v33, v31, v33
    v_max_u32 v32, v18, v35
    v_min_u32 v35, v18, v35
    v_max_u32 v21, v30, v29
    v_min_u32 v29, v30, v29
    v_max_u32 v15, v23, v26
    v_min_u32 v26, v23, v26
    v_max_u32 v34, v28, v32
    v_min_u32 v32, v28, v32
    v_max_u32 v36, v33, v35
    v_min_u32 v35, v33, v35
    v_max_u32 v39, v21, v15
    v_min_u32 v15, v21, v15
    v_max_u32 v37, v29, v26
    v_min_u32 v26, v29, v26
    s_nop 1
    v_max_u32 v9, v26, v34 row_mirror row_mask:0xf bank_mask:0xf
    v_max_u32 v24, v37, v32 row_mirror row_mask:0xf bank_mask:0xf
    v_max_u32 v10, v15, v36 row_mirror row_mask:0xf bank_mask:0xf
    v_max_u32 v8, v39, v35 row_mirror row_mask:0xf bank_mask:0xf
    v_max_u32 v12, v35, v39 row_mirror row_mask:0xf bank_mask:0xf
    v_max_u32 v38, v36, v15 row_mirror row_mask:0xf bank_mask:0xf
    v_max_u32 v25, v32, v37 row_mirror row_mask:0xf bank_mask:0xf
    v_max_u32 v20, v34, v26 row_mirror row_mask:0xf bank_mask:0xf
    v_max_u32 v13, v9, v12
    v_min_u32 v12, v9, v12
    v_max_u32 v27, v24, v38
    v_min_u32 v38, v24, v38
    v_max_u32 v11, v10, v25
    v_min_u32 v25, v10, v25
    v_max_u32 v14, v8, v20
    v_min_u32 v20, v8, v20
    v_max_u32 v19, v13, v11
    v_min_u32 v11, v13, v11
    v_max_u32 v22, v27, v14
    v_min_u32 v14, v27, v14
    v_max_u32 v31, v12, v25
    v_min_u32 v25, v12, v25
    v_max_u32 v18, v38, v20
    v_min_u32 v20, v38, v20
    v_max_u32 v30, v19, v22
    v_min_u32 v22, v19, v22
    v_max_u32 v23, v11, v14
    v_min_u32 v14, v11, v14
    v_max_u32 v28, v31, v18
    v_min_u32 v18, v31, v18
    v_max_u32 v33, v25, v20
    v_min_u32 v20, v25, v20
    s_nop 1
    v_max_u32 v21, v20, v30 row_bcast:15 row_mask:0xa bank_mask:0xf
    v_max_u32 v29, v33, v22 row_bcast:15 row_mask:0xa bank_mask:0xf
    v_max_u32 v34, v18, v23 row_bcast:15 row_mask:0xa bank_mask:0xf
    v_max_u32 v32, v28, v14 row_bcast:15 row_mask:0xa bank_mask:0xf
    v_max_u32 v36, v14, v28 row_bcast:15 row_mask:0xa bank_mask:0xf
    v_max_u32 v35, v23, v18 row_bcast:15 row_mask:0xa bank_mask:0xf
    v_max_u32 v39, v22, v33 row_bcast:15 row_mask:0xa bank_mask:0xf
    v_max_u32 v15, v30, v20 row_bcast:15 row_mask:0xa bank_mask:0xf
    v_max_u32 v37, v21, v36
    v_min_u32 v36, v21, v36
    v_max_u32 v26, v29, v35
    v_min_u32 v35, v29, v35
    v_max_u32 v9, v34, v39
    v_min_u32 v39, v34, v39
    v_max_u32 v24, v32, v15
    v_min_u32 v15, v32, v15
    v_max_u32 v10, v37, v9
    v_min_u32 v9, v37, v9
    v_max_u32 v8, v26, v24
    v_min_u32 v24, v26, v24
    v_max_u32 v13, v36, v39
    v_min_u32 v39, v36, v39
    v_max_u32 v27, v35, v15
    v_min_u32 v15, v35, v15
    v_max_u32 v12, v10, v8
    v_min_u32 v8, v10, v8
    v_max_u32 v38, v9, v24
    v_min_u32 v24, v9, v24
    v_max_u32 v19, v13, v27
    v_min_u32 v27, v13, v27
    v_max_u32 v11, v39, v15
    v_min_u32 v15, v39, v15
    s_nop 1
    v_max_u32 v31, v15, v12 row_bcast:31 row_mask:0xc bank_mask:0xf
    v_max_u32 v25, v11, v8 row_bcast:31 row_mask:0xc bank_mask:0xf
    v_max_u32 v30, v27, v38 row_bcast:31 row_mask:0xc bank_mask:0xf
    v_max_u32 v22, v19, v24 row_bcast:31 row_mask:0xc bank_mask:0xf
    v_max_u32 v23, v24, v19 row_bcast:31 row_mask:0xc bank_mask:0xf
    v_max_u32 v14, v38, v27 row_bcast:31 row_mask:0xc bank_mask:0xf
    v_max_u32 v28, v8, v11 row_bcast:31 row_mask:0xc bank_mask:0xf
    v_max_u32 v18, v12, v15 row_bcast:31 row_mask:0xc bank_mask:0xf
    v_max_u32 v33, v31, v23
    v_min_u32 v23, v31, v23
    v_max_u32 v20, v25, v14
    v_min_u32 v14, v25, v14
    v_max_u32 v21, v30, v28
    v_min_u32 v28, v30, v28
    v_max_u32 v29, v22, v18
    v_min_u32 v18, v22, v18
    v_max_u32 v34, v33, v21
    v_min_u32 v21, v33, v21
    v_max_u32 v32, v20, v29
    v_min_u32 v29, v20, v29
    v_max_u32 v37, v23, v28
    v_min_u32 v28, v23, v28
    v_max_u32 v26, v14, v18
    v_min_u32 v18, v14, v18
    v_max_u32 v36, v34, v32
    v_min_u32 v32, v34, v32
    v_max_u32 v35, v21, v29
    v_min_u32 v29, v21, v29
    v_max_u32 v10, v37, v26
    v_min_u32 v26, v37, v26
    v_max_u32 v9, v28, v18
    v_min_u32 v18, v28, v18
    v_lshlrev_b32 v17, 5, v4
    v_cmp_eq_u32 vcc, 63, v1
    s_nop 0
    s_and_saveexec_b64 s[44:45], vcc
    ds_write_b32 v17, v36 offset:0
    ds_write_b32 v17, v32 offset:4
    ds_write_b32 v17, v35 offset:8
    ds_write_b32 v17, v29 offset:12
    ds_write_b32 v17, v10 offset:16
    ds_write_b32 v17, v26 offset:20
    ds_write_b32 v17, v9 offset:24
    ds_write_b32 v17, v18 offset:28
    s_mov_b64 exec, s[44:45]
    s_waitcnt lgkmcnt(0)
    s_barrier
    s_endpgm
K4_main:
    v_and_b32 v1, 63, v0
    v_and_b32 v2, 15, v1
    v_lshrrev_b32 v3, 4, v1
    v_subrev_u32 v0, 256, v0
    v_subrev_u32 v4, 4, v4
    s_lshl_b32 s12, s2, 5
    v_lshlrev_b32 v6, 11, v4
    v_lshl_add_u32 v6, v1, 4, v6
    s_mul_i32 s13, s2, 28672
    v_add_u32 v6, s13, v6
    s_waitcnt lgkmcnt(0)
    s_add_u32 s20, s4, 12582912
    s_addc_u32 s21, s5, 0
    s_mov_b32 s22, 3211264
    s_mov_b32 s23, 0x00020000
    s_mov_b32 s52, s6
    s_mov_b32 s53, s7
    s_mov_b32 s54, 1605632
    s_mov_b32 s55, 0x00020000
    s_movk_i32 s14, 14336
    buffer_load_dwordx4 v[128:131], v6, s[20:23], 0 offen
    buffer_load_dwordx4 v[132:135], v6, s[20:23], 0 offen offset:1024
    buffer_load_dwordx4 v[136:139], v6, s[20:23], s14 offen
    buffer_load_dwordx4 v[140:143], v6, s[20:23], s14 offen offset:1024
    v_lshlrev_b32 v112, 4, v0
    s_mul_i32 s60, s2, 14336
    s_add_u32 s14, s60, 7168
    buffer_load_dwordx4 v[144:147], v112, s[52:55], s60 offen
    buffer_load_dwordx4 v[148:151], v112, s[52:55], s14 offen
    s_add_u32 s28, s4, 16777216
    s_addc_u32 s29, s5, 0
    s_mov_b32 s30, 1835008
    s_mov_b32 s31, 0x00020000
    s_add_u32 s32, s4, 6291456
    s_addc_u32 s33, s5, 0
    s_mov_b32 s34, 1835008
    s_mov_b32 s35, 0x00020000
    s_add_u32 s40, s4, 69632
    s_addc_u32 s41, s5, 0
    s_mov_b32 s42, 14592
    s_mov_b32 s43, 0x00020000
    s_add_u32 s56, s4, 10485760
    s_addc_u32 s57, s5, 0
    s_mov_b32 s58, 1605632
    s_mov_b32 s59, 0x00020000
    v_lshlrev_b32 v7, 7, v4
    v_lshl_add_u32 v7, v3, 4, v7
    v_lshlrev_b32 v113, 12, v4
    v_lshl_add_u32 v113, v1, 4, v113
    v_add_u32 v113, 16384, v113
    v_lshlrev_b32 v114, 12, v4
    v_lshl_add_u32 v114, v3, 8, v114
    v_lshrrev_b32 v115, 2, v2
    v_lshl_add_u32 v114, v115, 5, v114
    v_and_b32 v115, 3, v2
    v_lshl_add_u32 v114, v115, 3, v114
    v_add_u32 v114, 16384, v114
    v_and_b32 v16, 1, v1
    v_cmp_eq_u32 s[46:47], 1, v16
    v_and_b32 v16, 2, v1
    v_cmp_eq_u32 s[48:49], 2, v16
    v_and_b32 v16, 4, v1
    v_cmp_eq_u32 s[50:51], 4, v16
    v_and_b32 v57, 7, v1
    s_movk_i32 s13, 896
    v_mul_lo_u32 v57, v57, s13
    v_add_u32 v57, v57, v7
    v_bfrev_b32 v56, 1
    v_cmp_gt_u32 vcc, 8, v2
    s_nop 1
    v_cndmask_b32 v57, v56, v57, vcc
    v_lshlrev_b32 v58, 2, v0
    v_cmp_gt_u32 vcc, 8, v0
    s_nop 1
    v_cndmask_b32 v56, v56, v58, vcc
    v_lshlrev_b32 v59, 11, v4
    v_lshl_add_u32 v59, v1, 4, v59
    v_lshrrev_b32 v60, 4, v0
    v_lshrrev_b32 v61, 2, v60
    v_lshlrev_b32 v61, 8, v61
    v_lshl_add_u32 v61, v2, 4, v61
    v_and_b32 v62, 3, v60
    v_lshl_add_u32 v61, v62, 2, v61
    v_lshlrev_b32 v62, 5, v2
    v_lshl_add_u32 v62, v60, 2, v62
    v_and_b32 v17, 3, v1
    v_lshlrev_b32 v17, 5, v17
    s_mov_b32 s15, 3216550459
    s_waitcnt vmcnt(2)
    ds_write_b128 v113, v[128:131]
    ds_write_b128 v113, v[132:135] offset:1024
    ds_write_b128 v113, v[136:139] offset:2048
    ds_write_b128 v113, v[140:143] offset:3072
    s_waitcnt lgkmcnt(0)
    ds_read_b64_tr_b16 v[64:65], v114 offset:0
    ds_read_b64_tr_b16 v[66:67], v114 offset:128
    ds_read_b64_tr_b16 v[68:69], v114 offset:1024
    ds_read_b64_tr_b16 v[70:71], v114 offset:1152
    ds_read_b64_tr_b16 v[72:73], v114 offset:2048
    ds_read_b64_tr_b16 v[74:75], v114 offset:2176
    ds_read_b64_tr_b16 v[76:77], v114 offset:3072
    ds_read_b64_tr_b16 v[78:79], v114 offset:3200
    s_barrier
    ds_read_b128 v[8:11], v17
    ds_read_b128 v[12:15], v17 offset:16
    s_waitcnt lgkmcnt(0)
    v_max_u32 v18, v15, v8 quad_perm:[1,0,3,2] row_mask:0xf bank_mask:0xf
    v_max_u32 v19, v14, v9 quad_perm:[1,0,3,2] row_mask:0xf bank_mask:0xf
    v_max_u32 v20, v13, v10 quad_perm:[1,0,3,2] row_mask:0xf bank_mask:0xf
    v_max_u32 v21, v12, v11 quad_perm:[1,0,3,2] row_mask:0xf bank_mask:0xf
    v_max_u32 v22, v11, v12 quad_perm:[1,0,3,2] row_mask:0xf bank_mask:0xf
    v_max_u32 v23, v10, v13 quad_perm:[1,0,3,2] row_mask:0xf bank_mask:0xf
    v_max_u32 v24, v9, v14 quad_perm:[1,0,3,2] row_mask:0xf bank_mask:0xf
    v_max_u32 v25, v8, v15 quad_perm:[1,0,3,2] row_mask:0xf bank_mask:0xf
    v_max_u32 v26, v18, v22
    v_min_u32 v22, v18, v22
    v_max_u32 v27, v19, v23
    v_min_u32 v23, v19, v23
    v_max_u32 v28, v20, v24
    v_min_u32 v24, v20, v24
    v_max_u32 v29, v21, v25
    v_min_u32 v25, v21, v25
    v_max_u32 v30, v26, v28
    v_min_u32 v28, v26, v28
    v_max_u32 v31, v27, v29
    v_min_u32 v29, v27, v29
    v_max_u32 v32, v22, v24
    v_min_u32 v24, v22, v24
    v_max_u32 v33, v23, v25
    v_min_u32 v25, v23, v25
    v_max_u32 v34, v30, v31
    v_min_u32 v31, v30, v31
    v_max_u32 v35, v28, v29
    v_min_u32 v29, v28, v29
    v_max_u32 v36, v32, v33
    v_min_u32 v33, v32, v33
    v_max_u32 v37, v24, v25
    v_min_u32 v25, v24, v25
    s_nop 1
    v_max_u32 v38, v25, v34 quad_perm:[2,3,0,1] row_mask:0xf bank_mask:0xf
    v_max_u32 v39, v37, v31 quad_perm:[2,3,0,1] row_mask:0xf bank_mask:0xf
    v_max_u32 v8, v33, v35 quad_perm:[2,3,0,1] row_mask:0xf bank_mask:0xf
    v_max_u32 v9, v36, v29 quad_perm:[2,3,0,1] row_mask:0xf bank_mask:0xf
    v_max_u32 v10, v29, v36 quad_perm:[2,3,0,1] row_mask:0xf bank_mask:0xf
    v_max_u32 v11, v35, v33 quad_perm:[2,3,0,1] row_mask:0xf bank_mask:0xf
    v_max_u32 v12, v31, v37 quad_perm:[2,3,0,1] row_mask:0xf bank_mask:0xf
    v_max_u32 v13, v34, v25 quad_perm:[2,3,0,1] row_mask:0xf bank_mask:0xf
    v_max_u32 v14, v38, v10
    v_min_u32 v10, v38, v10
    v_max_u32 v15, v39, v11
    v_min_u32 v11, v39, v11
    v_max_u32 v18, v8, v12
    v_min_u32 v12, v8, v12
    v_max_u32 v19, v9, v13
    v_min_u32 v13, v9, v13
    v_max_u32 v20, v14, v18
    v_min_u32 v18, v14, v18
    v_max_u32 v21, v15, v19
    v_min_u32 v19, v15, v19
    v_max_u32 v26, v10, v12
    v_min_u32 v12, v10, v12
    v_max_u32 v27, v11, v13
    v_min_u32 v13, v11, v13
    v_max_u32 v22, v20, v21
    v_min_u32 v21, v20, v21
    v_max_u32 v23, v18, v19
    v_min_u32 v19, v18, v19
    v_max_u32 v30, v26, v27
    v_min_u32 v27, v26, v27
    v_max_u32 v28, v12, v13
    v_min_u32 v13, v12, v13
    v_cndmask_b32 v40, v22, v21, s[46:47]
    v_cndmask_b32 v41, v23, v19, s[46:47]
    v_cndmask_b32 v42, v30, v27, s[46:47]
    v_cndmask_b32 v43, v28, v13, s[46:47]
    v_cndmask_b32 v40, v40, v41, s[48:49]
    v_cndmask_b32 v42, v42, v43, s[48:49]
    v_cndmask_b32 v40, v40, v42, s[50:51]
    v_and_b32 v41, 0x7ff, v40
    v_sub_u32 v41, 2047, v41
    v_mul_lo_u32 v42, v41, s13
    v_add_u32 v42, v42, v7
    buffer_load_dwordx4 v[44:47], v42, s[28:31], 0 offen
    buffer_load_dwordx4 v[48:51], v42, s[28:31], 0 offen offset:64
    s_waitcnt vmcnt(2)
    ds_write_b128 v112, v[144:147] offset:45056
    ds_write_b128 v112, v[148:151] offset:52224
    v_lshlrev_b32 v112, 1, v0
    s_cmp_lg_u32 s2, 0
    s_cbranch_scc1 K4_nosel
    buffer_load_dwordx4 v[116:119], v42, s[32:35], 0 offen
    buffer_load_dwordx4 v[120:123], v42, s[32:35], 0 offen offset:64
    v_and_b32 v54, 0xffff0000, v40
    v_ashrrev_i32 v55, 31, v54
    v_not_b32 v55, v55
    v_or_b32 v55, 0x80000000, v55
    v_xor_b32 v54, v54, v55
    v_and_b32 v54, 0xffff0000, v54
    v_mul_f32 v55, s15, v54
    v_exp_f32 v55, v55
    s_nop 0
    v_add_f32 v55, 1.0, v55
    v_rcp_f32 v55, v55
    s_nop 0
    v_cvt_pk_bf16_f32 v55, v55, v55
    v_and_b32 v55, 0xffff0000, v55
    buffer_store_dword v41, v56, s[40:43], 0 offen sc1
    buffer_store_dword v55, v56, s[40:43], 0 offen offset:32 sc1
    s_movk_i32 s13, 7168
    s_waitcnt vmcnt(2)
    buffer_store_dwordx4 v[116:119], v57, s[40:43], 0 offen offset:256 sc1
    buffer_store_dwordx4 v[120:123], v57, s[40:43], 0 offen offset:320 sc1
    buffer_store_dwordx4 v[44:47], v57, s[40:43], s13 offen offset:256 sc1
    buffer_store_dwordx4 v[48:51], v57, s[40:43], s13 offen offset:320 sc1
    s_branch K4_sel2
K4_nosel:
    s_waitcnt lgkmcnt(0)
    s_waitcnt vmcnt(0)
K4_sel2:
    s_waitcnt lgkmcnt(0)
    v_mfma_f32_16x16x32_bf16 v[8:11], v[44:47], v[64:67], 0
    v_mfma_f32_16x16x32_bf16 v[12:15], v[44:47], v[72:75], 0
    v_mfma_f32_16x16x32_bf16 v[8:11], v[48:51], v[68:71], v[8:11]
    v_mfma_f32_16x16x32_bf16 v[12:15], v[48:51], v[76:79], v[12:15]
    s_nop 6
    ds_write_b128 v59, v[8:11] offset:256
    ds_write_b128 v59, v[12:15] offset:1280
    s_waitcnt lgkmcnt(0)
    s_barrier
    v_cmp_gt_u32 vcc, 128, v0
    s_nop 0
    s_and_saveexec_b64 s[44:45], vcc
    s_cbranch_execz K4_join
    ds_read_b32 v64, v61 offset:256
    ds_read_b32 v72, v61 offset:1280
    ds_read_b32 v65, v61 offset:2304
    ds_read_b32 v73, v61 offset:3328
    ds_read_b32 v66, v61 offset:4352
    ds_read_b32 v74, v61 offset:5376
    ds_read_b32 v67, v61 offset:6400
    ds_read_b32 v75, v61 offset:7424
    ds_read_b32 v68, v61 offset:8448
    ds_read_b32 v76, v61 offset:9472
    ds_read_b32 v69, v61 offset:10496
    ds_read_b32 v77, v61 offset:11520
    ds_read_b32 v70, v61 offset:12544
    ds_read_b32 v78, v61 offset:13568
    s_waitcnt lgkmcnt(0)
    v_add_f32 v64, v64, v65
    v_add_f32 v72, v72, v73
    v_add_f32 v66, v66, v67
    v_add_f32 v74, v74, v75
    v_add_f32 v68, v68, v69
    v_add_f32 v76, v76, v77
    v_add_f32 v64, v64, v70
    v_add_f32 v72, v72, v78
    v_add_f32 v66, v66, v68
    v_add_f32 v74, v74, v76
    v_add_f32 v64, v64, v66
    v_add_f32 v65, v72, v74
    v_cvt_pk_bf16_f32 v64, v64, v65
    v_and_b32 v65, 0xffff0000, v64
    v_lshlrev_b32 v64, 16, v64
    v_mul_f32 v72, s15, v64
    v_exp_f32 v72, v72
    s_nop 0
    v_add_f32 v72, 1.0, v72
    v_rcp_f32 v72, v72
    s_nop 0
    v_mul_f32 v64, v64, v72
    v_cvt_pk_bf16_f32 v64, v64, v64
    v_and_b32 v64, 0xffff0000, v64
    v_mul_f32 v64, v64, v65
    v_cvt_pk_bf16_f32 v64, v64, v64
    v_and_b32 v64, 0xffff0000, v64
    ds_write_b32 v62, v64 offset:14848
    s_waitcnt lgkmcnt(0)
K4_join:
    s_mov_b64 exec, s[44:45]
    ds_read_u16 v96, v112 offset:45056
    ds_read_u16 v97, v112 offset:45952
    ds_read_u16 v98, v112 offset:46848
    ds_read_u16 v99, v112 offset:47744
    ds_read_u16 v100, v112 offset:48640
    ds_read_u16 v101, v112 offset:49536
    ds_read_u16 v102, v112 offset:50432
    ds_read_u16 v103, v112 offset:51328
    ds_read_u16 v104, v112 offset:52224
    ds_read_u16 v105, v112 offset:53120
    ds_read_u16 v106, v112 offset:54016
    ds_read_u16 v107, v112 offset:54912
    ds_read_u16 v108, v112 offset:55808
    ds_read_u16 v109, v112 offset:56704
    ds_read_u16 v110, v112 offset:57600
    ds_read_u16 v111, v112 offset:58496
    s_waitcnt lgkmcnt(0)
    v_lshlrev_b32 v96, 16, v96
    v_lshlrev_b32 v97, 16, v97
    v_lshlrev_b32 v98, 16, v98
    v_lshlrev_b32 v99, 16, v99
    v_lshlrev_b32 v100, 16, v100
    v_lshlrev_b32 v101, 16, v101
    v_lshlrev_b32 v102, 16, v102
    v_lshlrev_b32 v103, 16, v103
    v_lshlrev_b32 v104, 16, v104
    v_lshlrev_b32 v105, 16, v105
    v_lshlrev_b32 v106, 16, v106
    v_lshlrev_b32 v107, 16, v107
    v_lshlrev_b32 v108, 16, v108
    v_lshlrev_b32 v109, 16, v109
    v_lshlrev_b32 v110, 16, v110
    v_lshlrev_b32 v111, 16, v111
    s_barrier
    v_mov_b32 v17, 14848
    ds_read_b128 v[64:67], v17 offset:0
    ds_read_b128 v[68:71], v17 offset:16
    ds_read_b128 v[72:75], v17 offset:32
    ds_read_b128 v[76:79], v17 offset:48
    ds_read_b128 v[80:83], v17 offset:64
    ds_read_b128 v[84:87], v17 offset:80
    ds_read_b128 v[88:91], v17 offset:96
    ds_read_b128 v[92:95], v17 offset:112
    ds_read_b128 v[128:131], v17 offset:128
    ds_read_b128 v[132:135], v17 offset:144
    ds_read_b128 v[136:139], v17 offset:160
    ds_read_b128 v[140:143], v17 offset:176
    ds_read_b128 v[144:147], v17 offset:192
    ds_read_b128 v[148:151], v17 offset:208
    ds_read_b128 v[152:155], v17 offset:224
    ds_read_b128 v[156:159], v17 offset:240
    s_waitcnt lgkmcnt(14)
    v_pk_mul_f32 v[8:9], v[64:65], v[96:97] op_sel_hi:[1,0]
    v_pk_mul_f32 v[10:11], v[66:67], v[96:97] op_sel_hi:[1,0]
    v_pk_mul_f32 v[12:13], v[68:69], v[96:97] op_sel_hi:[1,0]
    v_pk_mul_f32 v[14:15], v[70:71], v[96:97] op_sel_hi:[1,0]
    s_waitcnt lgkmcnt(12)
    v_pk_fma_f32 v[8:9], v[72:73], v[96:97], v[8:9] op_sel:[0,1,0] op_sel_hi:[1,1,1]
    v_pk_fma_f32 v[10:11], v[74:75], v[96:97], v[10:11] op_sel:[0,1,0] op_sel_hi:[1,1,1]
    v_pk_fma_f32 v[12:13], v[76:77], v[96:97], v[12:13] op_sel:[0,1,0] op_sel_hi:[1,1,1]
    v_pk_fma_f32 v[14:15], v[78:79], v[96:97], v[14:15] op_sel:[0,1,0] op_sel_hi:[1,1,1]
    s_waitcnt lgkmcnt(10)
    v_pk_fma_f32 v[8:9], v[80:81], v[98:99], v[8:9] op_sel_hi:[1,0,1]
    v_pk_fma_f32 v[10:11], v[82:83], v[98:99], v[10:11] op_sel_hi:[1,0,1]
    v_pk_fma_f32 v[12:13], v[84:85], v[98:99], v[12:13] op_sel_hi:[1,0,1]
    v_pk_fma_f32 v[14:15], v[86:87], v[98:99], v[14:15] op_sel_hi:[1,0,1]
    s_waitcnt lgkmcnt(8)
    v_pk_fma_f32 v[8:9], v[88:89], v[98:99], v[8:9] op_sel:[0,1,0] op_sel_hi:[1,1,1]
    v_pk_fma_f32 v[10:11], v[90:91], v[98:99], v[10:11] op_sel:[0,1,0] op_sel_hi:[1,1,1]
    v_pk_fma_f32 v[12:13], v[92:93], v[98:99], v[12:13] op_sel:[0,1,0] op_sel_hi:[1,1,1]
    v_pk_fma_f32 v[14:15], v[94:95], v[98:99], v[14:15] op_sel:[0,1,0] op_sel_hi:[1,1,1]
    s_waitcnt lgkmcnt(6)
    v_pk_fma_f32 v[8:9], v[128:129], v[100:101], v[8:9] op_sel_hi:[1,0,1]
    v_pk_fma_f32 v[10:11], v[130:131], v[100:101], v[10:11] op_sel_hi:[1,0,1]
    v_pk_fma_f32 v[12:13], v[132:133], v[100:101], v[12:13] op_sel_hi:[1,0,1]
    v_pk_fma_f32 v[14:15], v[134:135], v[100:101], v[14:15] op_sel_hi:[1,0,1]
    s_waitcnt lgkmcnt(4)
    v_pk_fma_f32 v[8:9], v[136:137], v[100:101], v[8:9] op_sel:[0,1,0] op_sel_hi:[1,1,1]
    v_pk_fma_f32 v[10:11], v[138:139], v[100:101], v[10:11] op_sel:[0,1,0] op_sel_hi:[1,1,1]
    v_pk_fma_f32 v[12:13], v[140:141], v[100:101], v[12:13] op_sel:[0,1,0] op_sel_hi:[1,1,1]
    v_pk_fma_f32 v[14:15], v[142:143], v[100:101], v[14:15] op_sel:[0,1,0] op_sel_hi:[1,1,1]
    s_waitcnt lgkmcnt(2)
    v_pk_fma_f32 v[8:9], v[144:145], v[102:103], v[8:9] op_sel_hi:[1,0,1]
    v_pk_fma_f32 v[10:11], v[146:147], v[102:103], v[10:11] op_sel_hi:[1,0,1]
    v_pk_fma_f32 v[12:13], v[148:149], v[102:103], v[12:13] op_sel_hi:[1,0,1]
    v_pk_fma_f32 v[14:15], v[150:151], v[102:103], v[14:15] op_sel_hi:[1,0,1]
    s_waitcnt lgkmcnt(0)
    v_pk_fma_f32 v[8:9], v[152:153], v[102:103], v[8:9] op_sel:[0,1,0] op_sel_hi:[1,1,1]
    v_pk_fma_f32 v[10:11], v[154:155], v[102:103], v[10:11] op_sel:[0,1,0] op_sel_hi:[1,1,1]
    v_pk_fma_f32 v[12:13], v[156:157], v[102:103], v[12:13] op_sel:[0,1,0] op_sel_hi:[1,1,1]
    v_pk_fma_f32 v[14:15], v[158:159], v[102:103], v[14:15] op_sel:[0,1,0] op_sel_hi:[1,1,1]
    ds_read_b128 v[64:67], v17 offset:256
    ds_read_b128 v[68:71], v17 offset:272
    ds_read_b128 v[72:75], v17 offset:288
    ds_read_b128 v[76:79], v17 offset:304
    ds_read_b128 v[80:83], v17 offset:320
    ds_read_b128 v[84:87], v17 offset:336
    ds_read_b128 v[88:91], v17 offset:352
    ds_read_b128 v[92:95], v17 offset:368
    ds_read_b128 v[128:131], v17 offset:384
    ds_read_b128 v[132:135], v17 offset:400
    ds_read_b128 v[136:139], v17 offset:416
    ds_read_b128 v[140:143], v17 offset:432
    ds_read_b128 v[144:147], v17 offset:448
    ds_read_b128 v[148:151], v17 offset:464
    ds_read_b128 v[152:155], v17 offset:480
    ds_read_b128 v[156:159], v17 offset:496
    s_waitcnt lgkmcnt(14)
    v_pk_fma_f32 v[8:9], v[64:65], v[104:105], v[8:9] op_sel_hi:[1,0,1]
    v_pk_fma_f32 v[10:11], v[66:67], v[104:105], v[10:11] op_sel_hi:[1,0,1]
    v_pk_fma_f32 v[12:13], v[68:69], v[104:105], v[12:13] op_sel_hi:[1,0,1]
    v_pk_fma_f32 v[14:15], v[70:71], v[104:105], v[14:15] op_sel_hi:[1,0,1]
    s_waitcnt lgkmcnt(12)
    v_pk_fma_f32 v[8:9], v[72:73], v[104:105], v[8:9] op_sel:[0,1,0] op_sel_hi:[1,1,1]
    v_pk_fma_f32 v[10:11], v[74:75], v[104:105], v[10:11] op_sel:[0,1,0] op_sel_hi:[1,1,1]
    v_pk_fma_f32 v[12:13], v[76:77], v[104:105], v[12:13] op_sel:[0,1,0] op_sel_hi:[1,1,1]
    v_pk_fma_f32 v[14:15], v[78:79], v[104:105], v[14:15] op_sel:[0,1,0] op_sel_hi:[1,1,1]
    s_waitcnt lgkmcnt(10)
    v_pk_fma_f32 v[8:9], v[80:81], v[106:107], v[8:9] op_sel_hi:[1,0,1]
    v_pk_fma_f32 v[10:11], v[82:83], v[106:107], v[10:11] op_sel_hi:[1,0,1]
    v_pk_fma_f32 v[12:13], v[84:85], v[106:107], v[12:13] op_sel_hi:[1,0,1]
    v_pk_fma_f32 v[14:15], v[86:87], v[106:107], v[14:15] op_sel_hi:[1,0,1]
    s_waitcnt lgkmcnt(8)
    v_pk_fma_f32 v[8:9], v[88:89], v[106:107], v[8:9] op_sel:[0,1,0] op_sel_hi:[1,1,1]
    v_pk_fma_f32 v[10:11], v[90:91], v[106:107], v[10:11] op_sel:[0,1,0] op_sel_hi:[1,1,1]
    v_pk_fma_f32 v[12:13], v[92:93], v[106:107], v[12:13] op_sel:[0,1,0] op_sel_hi:[1,1,1]
    v_pk_fma_f32 v[14:15], v[94:95], v[106:107], v[14:15] op_sel:[0,1,0] op_sel_hi:[1,1,1]
    s_waitcnt lgkmcnt(6)
    v_pk_fma_f32 v[8:9], v[128:129], v[108:109], v[8:9] op_sel_hi:[1,0,1]
    v_pk_fma_f32 v[10:11], v[130:131], v[108:109], v[10:11] op_sel_hi:[1,0,1]
    v_pk_fma_f32 v[12:13], v[132:133], v[108:109], v[12:13] op_sel_hi:[1,0,1]
    v_pk_fma_f32 v[14:15], v[134:135], v[108:109], v[14:15] op_sel_hi:[1,0,1]
    s_waitcnt lgkmcnt(4)
    v_pk_fma_f32 v[8:9], v[136:137], v[108:109], v[8:9] op_sel:[0,1,0] op_sel_hi:[1,1,1]
    v_pk_fma_f32 v[10:11], v[138:139], v[108:109], v[10:11] op_sel:[0,1,0] op_sel_hi:[1,1,1]
    v_pk_fma_f32 v[12:13], v[140:141], v[108:109], v[12:13] op_sel:[0,1,0] op_sel_hi:[1,1,1]
    v_pk_fma_f32 v[14:15], v[142:143], v[108:109], v[14:15] op_sel:[0,1,0] op_sel_hi:[1,1,1]
    s_waitcnt lgkmcnt(2)
    v_pk_fma_f32 v[8:9], v[144:145], v[110:111], v[8:9] op_sel_hi:[1,0,1]
    v_pk_fma_f32 v[10:11], v[146:147], v[110:111], v[10:11] op_sel_hi:[1,0,1]
    v_pk_fma_f32 v[12:13], v[148:149], v[110:111], v[12:13] op_sel_hi:[1,0,1]
    v_pk_fma_f32 v[14:15], v[150:151], v[110:111], v[14:15] op_sel_hi:[1,0,1]
    s_waitcnt lgkmcnt(0)
    v_pk_fma_f32 v[8:9], v[152:153], v[110:111], v[8:9] op_sel:[0,1,0] op_sel_hi:[1,1,1]
    v_pk_fma_f32 v[10:11], v[154:155], v[110:111], v[10:11] op_sel:[0,1,0] op_sel_hi:[1,1,1]
    v_pk_fma_f32 v[12:13], v[156:157], v[110:111], v[12:13] op_sel:[0,1,0] op_sel_hi:[1,1,1]
    v_pk_fma_f32 v[14:15], v[158:159], v[110:111], v[14:15] op_sel:[0,1,0] op_sel_hi:[1,1,1]
    s_mul_i32 s60, s2, 14336
    v_lshlrev_b32 v17, 2, v0
    s_add_u32 s14, s60, 0
    buffer_store_dword v8, v17, s[56:59], s14 offen sc1
    s_add_u32 s14, s60, 1792
    buffer_store_dword v9, v17, s[56:59], s14 offen sc1
    s_add_u32 s14, s60, 3584
    buffer_store_dword v10, v17, s[56:59], s14 offen sc1
    s_add_u32 s14, s60, 5376
    buffer_store_dword v11, v17, s[56:59], s14 offen sc1
    s_add_u32 s14, s60, 7168
    buffer_store_dword v12, v17, s[56:59], s14 offen sc1
    s_add_u32 s14, s60, 8960
    buffer_store_dword v13, v17, s[56:59], s14 offen sc1
    s_add_u32 s14, s60, 10752
    buffer_store_dword v14, v17, s[56:59], s14 offen sc1
    s_add_u32 s14, s60, 12544
    buffer_store_dword v15, v17, s[56:59], s14 offen sc1
K4_end:
    s_endpgm
.globl k5_kernel
.p2align 8
.type k5_kernel,@function
k5_kernel:
    s_cmp_ge_u32 s2, 56
    s_cbranch_scc1 K5_end
    s_load_dwordx2 s[4:5], s[0:1], 144
    s_load_dwordx2 s[10:11], s[0:1], 128
    s_mul_i32 s12, s2, 37
    s_lshr_b32 s12, s12, 8
    s_mul_i32 s13, s12, 7
    s_sub_u32 s13, s2, s13
    v_and_b32 v1, 63, v0
    v_lshrrev_b32 v2, 6, v0
    s_mov_b32 s14, 401408
    v_mul_lo_u32 v3, v2, s14
    v_lshl_add_u32 v3, v1, 2, v3
    s_mul_i32 s15, s12, 1792
    s_lshl_b32 s16, s13, 8
    s_add_u32 s15, s15, s16
    v_add_u32 v3, s15, v3
    s_lshl_b32 s16, s13, 7
    v_lshl_add_u32 v4, v1, 1, s16
    s_mul_i32 s17, s12, 896
    s_lshl_b32 s18, s12, 2
    s_waitcnt lgkmcnt(0)
    s_add_u32 s20, s4, 10485760
    s_addc_u32 s21, s5, 0
    s_mov_b32 s22, 1605632
    s_mov_b32 s23, 0x00020000
    s_mov_b32 s28, s4
    s_mov_b32 s29, s5
    s_mov_b32 s30, 5376
    s_mov_b32 s31, 0x00020000
    s_add_u32 s40, s4, 69632
    s_addc_u32 s41, s5, 0
    s_mov_b32 s42, 14592
    s_mov_b32 s43, 0x00020000
    s_mov_b32 s44, s10
    s_mov_b32 s45, s11
    s_mov_b32 s46, 1835008
    s_mov_b32 s47, 0x00020000
    s_add_u32 s6, s4, 69632
    s_addc_u32 s7, s5, 0
    s_add_u32 s6, s6, s18
    s_addc_u32 s7, s7, 0
    s_load_dword s24, s[6:7], 0
    s_load_dword s25, s[6:7], 32
    s_mov_b32 s14, 0
    buffer_load_dword v8, v3, s[20:23], s14 offen
    s_mov_b32 s14, 14336
    buffer_load_dword v9, v3, s[20:23], s14 offen
    s_mov_b32 s14, 28672
    buffer_load_dword v10, v3, s[20:23], s14 offen
    s_mov_b32 s14, 43008
    buffer_load_dword v11, v3, s[20:23], s14 offen
    s_mov_b32 s14, 57344
    buffer_load_dword v12, v3, s[20:23], s14 offen
    s_mov_b32 s14, 71680
    buffer_load_dword v13, v3, s[20:23], s14 offen
    s_mov_b32 s14, 86016
    buffer_load_dword v14, v3, s[20:23], s14 offen
    s_mov_b32 s14, 100352
    buffer_load_dword v15, v3, s[20:23], s14 offen
    s_mov_b32 s14, 114688
    buffer_load_dword v16, v3, s[20:23], s14 offen
    s_mov_b32 s14, 129024
    buffer_load_dword v17, v3, s[20:23], s14 offen
    s_mov_b32 s14, 143360
    buffer_load_dword v18, v3, s[20:23], s14 offen
    s_mov_b32 s14, 157696
    buffer_load_dword v19, v3, s[20:23], s14 offen
    s_mov_b32 s14, 172032
    buffer_load_dword v20, v3, s[20:23], s14 offen
    s_mov_b32 s14, 186368
    buffer_load_dword v21, v3, s[20:23], s14 offen
    s_mov_b32 s14, 200704
    buffer_load_dword v22, v3, s[20:23], s14 offen
    s_mov_b32 s14, 215040
    buffer_load_dword v23, v3, s[20:23], s14 offen
    s_mov_b32 s14, 229376
    buffer_load_dword v24, v3, s[20:23], s14 offen
    s_mov_b32 s14, 243712
    buffer_load_dword v25, v3, s[20:23], s14 offen
    s_mov_b32 s14, 258048
    buffer_load_dword v26, v3, s[20:23], s14 offen
    s_mov_b32 s14, 272384
    buffer_load_dword v27, v3, s[20:23], s14 offen
    s_mov_b32 s14, 286720
    buffer_load_dword v28, v3, s[20:23], s14 offen
    s_mov_b32 s14, 301056
    buffer_load_dword v29, v3, s[20:23], s14 offen
    s_mov_b32 s14, 315392
    buffer_load_dword v30, v3, s[20:23], s14 offen
    s_mov_b32 s14, 329728
    buffer_load_dword v31, v3, s[20:23], s14 offen
    s_mov_b32 s14, 344064
    buffer_load_dword v32, v3, s[20:23], s14 offen
    s_mov_b32 s14, 358400
    buffer_load_dword v33, v3, s[20:23], s14 offen
    s_mov_b32 s14, 372736
    buffer_load_dword v34, v3, s[20:23], s14 offen
    s_mov_b32 s14, 387072
    buffer_load_dword v35, v3, s[20:23], s14 offen
    s_movk_i32 s14, 4480
    buffer_load_ushort v40, v4, s[28:31], s14 offen
    s_add_u32 s14, s17, 256
    buffer_load_ushort v41, v4, s[40:43], s14 offen
    s_add_u32 s14, s17, 7424
    buffer_load_ushort v42, v4, s[40:43], s14 offen
    s_waitcnt vmcnt(27)
    v_add_f32 v8, v8, v9
    v_add_f32 v10, v10, v11
    s_waitcnt vmcnt(23)
    v_add_f32 v8, v8, v12
    v_add_f32 v10, v10, v13
    v_add_f32 v8, v8, v14
    v_add_f32 v10, v10, v15
    s_waitcnt vmcnt(19)
    v_add_f32 v8, v8, v16
    v_add_f32 v10, v10, v17
    v_add_f32 v8, v8, v18
    v_add_f32 v10, v10, v19
    s_waitcnt vmcnt(15)
    v_add_f32 v8, v8, v20
    v_add_f32 v10, v10, v21
    v_add_f32 v8, v8, v22
    v_add_f32 v10, v10, v23
    s_waitcnt vmcnt(11)
    v_add_f32 v8, v8, v24
    v_add_f32 v10, v10, v25
    v_add_f32 v8, v8, v26
    v_add_f32 v10, v10, v27
    s_waitcnt vmcnt(7)
    v_add_f32 v8, v8, v28
    v_add_f32 v10, v10, v29
    v_add_f32 v8, v8, v30
    v_add_f32 v10, v10, v31
    s_waitcnt vmcnt(3)
    v_add_f32 v8, v8, v32
    v_add_f32 v10, v10, v33
    v_add_f32 v8, v8, v34
    v_add_f32 v10, v10, v35
    v_add_f32 v8, v8, v10
    v_lshlrev_b32 v5, 2, v0
    ds_write_b32 v5, v8
    s_waitcnt lgkmcnt(0)
    s_barrier
    v_cmp_gt_u32 vcc, 64, v0
    s_nop 0
    s_and_saveexec_b64 s[48:49], vcc
    s_cbranch_execz K5_end
    ds_read_b32 v9, v5 offset:256
    ds_read_b32 v10, v5 offset:512
    ds_read_b32 v11, v5 offset:768
    s_waitcnt lgkmcnt(0)
    v_add_f32 v8, v8, v9
    v_add_f32 v10, v10, v11
    v_add_f32 v8, v8, v10
    v_cvt_pk_bf16_f32 v8, v8, v8
    v_and_b32 v8, 0xffff0000, v8
    v_mul_f32 v8, s25, v8
    v_cvt_pk_bf16_f32 v8, v8, v8
    v_and_b32 v8, 0xffff0000, v8
    s_waitcnt vmcnt(0)
    v_lshlrev_b32 v40, 16, v40
    v_lshlrev_b32 v41, 16, v41
    v_lshlrev_b32 v42, 16, v42
    v_add_f32 v8, v8, v42
    v_cvt_pk_bf16_f32 v8, v8, v8
    v_and_b32 v8, 0xffff0000, v8
    v_mul_f32 v8, v8, v40
    v_cvt_pk_bf16_f32 v8, v8, v8
    v_and_b32 v8, 0xffff0000, v8
    v_add_f32 v8, v8, v41
    v_cvt_pk_bf16_f32 v8, v8, v8
    s_and_b32 s24, s24, 0x7ff
    s_mul_i32 s24, s24, 896
    buffer_store_short v8, v4, s[44:47], s24 offen sc1
K5_end:
    s_endpgm
.section .rodata,"a"
.p2align 6
.amdhsa_kernel k12_kernel
  .amdhsa_next_free_vgpr 168
  .amdhsa_next_free_sgpr 96
  .amdhsa_accum_offset 168
  .amdhsa_group_segment_fixed_size 0
  .amdhsa_kernarg_size 152
  .amdhsa_user_sgpr_count 2
  .amdhsa_user_sgpr_kernarg_segment_ptr 1
  .amdhsa_system_sgpr_workgroup_id_x 1
  .amdhsa_float_denorm_mode_32 3
  .amdhsa_float_denorm_mode_16_64 3
.end_amdhsa_kernel
.p2align 6
.amdhsa_kernel k3_kernel
  .amdhsa_next_free_vgpr 120
  .amdhsa_next_free_sgpr 96
  .amdhsa_accum_offset 120
  .amdhsa_group_segment_fixed_size 0
  .amdhsa_kernarg_size 152
  .amdhsa_user_sgpr_count 2
  .amdhsa_user_sgpr_kernarg_segment_ptr 1
  .amdhsa_system_sgpr_workgroup_id_x 1
  .amdhsa_float_denorm_mode_32 3
  .amdhsa_float_denorm_mode_16_64 3
.end_amdhsa_kernel
.p2align 6
.amdhsa_kernel k4_kernel
  .amdhsa_next_free_vgpr 160
  .amdhsa_next_free_sgpr 96
  .amdhsa_accum_offset 160
  .amdhsa_group_segment_fixed_size 0
  .amdhsa_kernarg_size 152
  .amdhsa_user_sgpr_count 2
  .amdhsa_user_sgpr_kernarg_segment_ptr 1
  .amdhsa_system_sgpr_workgroup_id_x 1
  .amdhsa_float_denorm_mode_32 3
  .amdhsa_float_denorm_mode_16_64 3
.end_amdhsa_kernel
.p2align 6
.amdhsa_kernel k5_kernel
  .amdhsa_next_free_vgpr 48
  .amdhsa_next_free_sgpr 96
  .amdhsa_accum_offset 48
  .amdhsa_group_segment_fixed_size 0
  .amdhsa_kernarg_size 152
  .amdhsa_user_sgpr_count 2
  .amdhsa_user_sgpr_kernarg_segment_ptr 1
  .amdhsa_system_sgpr_workgroup_id_x 1
  .amdhsa_float_denorm_mode_32 3
  .amdhsa_float_denorm_mode_16_64 3
.end_amdhsa_kernel
```
